```python
import torch

def _softmax(x, axis=-1):
    return torch.softmax(x, dim=axis)
def _gelu(x):
    return torch.nn.functional.gelu(x, approximate="tanh")
def _silu(x):
    return torch.nn.functional.silu(x)
def _sigmoid(x):
    return torch.sigmoid(x)
def _layernorm(x, axis=-1, eps=1e-5):
    m = x.mean(dim=axis, keepdim=True)
    v = x.var(dim=axis, keepdim=True, unbiased=False)
    return (x - m) / torch.sqrt(v + eps)
def _scatter_add(tgt, idx, src, axis=0):
    return tgt.clone().index_add_(axis, idx, src)
def _segment_sum(src, seg, n):
    out = torch.zeros((n,) + src.shape[1:], dtype=src.dtype)
    return out.index_add_(0, seg, src)
def _pad(x, pw):
    flat = tuple(v for pair in reversed(pw) for v in pair)
    return torch.nn.functional.pad(x, flat)

kernel_name = 'standalone__paged_block_table_kv_pagedattention__sampling'

def setup_inputs():

    _w = (lambda a: (lambda t: t.to(torch.bfloat16) if t.is_floating_point() else t)(torch.as_tensor(a)))
    B, Hq, Hkv, Sq, Skv, D = 16, 32, 8, 32, 4096, 128
    bs = 16
    nbps = max(1, Skv // bs)
    num_phys = B * nbps + 4
    bt = torch.randperm(num_phys)[: B * nbps].reshape(B, nbps).to(torch.int64)
    cl = (nbps * bs - (torch.arange(1, B + 1, dtype=torch.int64) * 2654435761) % max(1, nbps * bs // 2)).to(torch.int64)
    return {
        "q": _w((lambda *s: torch.randn(*s, dtype=torch.bfloat16) * 0.8)(B, Hq, Sq, D)),
        "k_cache": _w((lambda *s: torch.randn(*s, dtype=torch.bfloat16) * 0.8)(num_phys, bs, Hkv, D)),
        "v_cache": _w((lambda *s: torch.randn(*s, dtype=torch.bfloat16) * 0.05)(num_phys, bs, Hkv, D)),
        "block_table": _w(bt),
        "context_lens": _w(cl),
    }

def reference(q, k_cache, v_cache, block_table, context_lens):
    B, Hq, Sq, D = q.shape
    bs = k_cache.shape[1]
    Hkv = k_cache.shape[2]
    nbps = block_table.shape[1]
    Skv = nbps * bs
    bt = block_table.reshape(-1)
    k = (lambda x, *d: x.permute(*d))(k_cache[bt].reshape(B, Skv, Hkv, D), 0, 2, 1, 3)
    v = (lambda x, *d: x.permute(*d))(v_cache[bt].reshape(B, Skv, Hkv, D), 0, 2, 1, 3)
    g = Hq // Hkv
    qg = q.reshape(B, Hkv, g, Sq, D)
    scores = torch.einsum("bhgqd,bhkd->bhgqk", qg, k) * (D ** -0.5)
    pos = torch.arange(Skv)
    msk = pos[None, :] < context_lens[:, None]
    scores = torch.where(msk[:, None, None, None, :], scores, -1e9)
    p = _softmax(scores, axis=-1)
    out = torch.einsum("bhgqk,bhkd->bhgqd", p, v)
    return out.reshape(B, Hq, Sq, D)
```

```asm
; @launch grid=(256,1,1) block=(512,1,1) lds=161856
.amdgcn_target "amdgcn-amd-amdhsa--gfx950"
.text
.globl standalone__paged_block_table_kv_pagedattention__sampling_kernel
.p2align 8
.type standalone__paged_block_table_kv_pagedattention__sampling_kernel,@function
standalone__paged_block_table_kv_pagedattention__sampling_kernel:
    s_cmp_ge_u32 s2, 256
    s_cbranch_scc1 L_end
    s_load_dwordx16 s[4:19], s[0:1], 0
    s_getpc_b64 s[24:25]
L_pc:
    s_lshr_b32 s26, s2, 3
    s_mul_i32 s26, s26, 1024
    v_lshl_add_u32 v37, v0, 7, s26
    v_min_u32 v37, L_end-L_pc, v37
    v_cmp_gt_u32 vcc, 8, v0
    s_and_saveexec_b64 s[26:27], vcc
    s_cbranch_execz L_nopf
    global_load_dword v36, v37, s[24:25]
L_nopf:
    s_mov_b64 exec, -1
    v_lshrrev_b32 v2, 6, v0
    v_and_b32 v1, 63, v0
    s_and_b32 s21, s2, 7
    v_readfirstlane_b32 s20, v2
    v_and_b32 v32, 15, v1
    v_lshlrev_b32 v31, 2, v32
    s_lshr_b32 s22, s2, 4
    s_bfe_u32 s23, s2, 0x10003
    s_and_b32 s24, s20, 6
    s_cmp_lg_u32 s24, 4
    s_cbranch_scc1 L_centry
    s_and_b32 s73, s20, 1
    s_lshl_b32 s24, s22, 10
    s_lshl2_add_u32 s24, s73, s24
    v_lshl_add_u32 v3, v1, 4, s24
    v_lshrrev_b32 v17, 4, v1
    v_xor_b32 v7, v32, v17
    v_lshlrev_b32 v7, 4, v7
    v_lshl_add_u32 v16, v17, 8, v7
    v_add_u32 v25, 192, v16
    v_add_u32 v26, 128, v16
    v_add_u32 v27, 64, v16
    v_add_u32 v24, 256, v16
    s_mov_b32 s42, 4194560
    s_mov_b32 s43, 0x20000
    s_lshl3_add_u32 s24, s22, s21
    s_lshl_b32 s24, s24, 15
    s_lshl_b32 s25, s73, 14
    s_add_u32 s24, s24, s25
    s_mul_i32 s25, s73, 17408
    s_add_u32 s25, s25, 104448
    s_waitcnt lgkmcnt(0)
    global_load_dword v30, v31, s[12:13]
    global_load_dword v4, v3, s[10:11]
    global_load_dword v5, v3, s[10:11] offset:8
    s_sub_u32 s40, s4, 256
    s_subb_u32 s41, s5, 0
    s_and_b32 s41, s41, 0xffff
    s_mov_b32 m0, s25
    s_add_u32 s25, s25, 4352
    buffer_load_dwordx4 v24, s[40:43], s24 offen offset:0  lds
    buffer_load_dwordx4 v25, s[40:43], s24 offen offset:1088  lds
    buffer_load_dwordx4 v26, s[40:43], s24 offen offset:2176  lds
    buffer_load_dwordx4 v27, s[40:43], s24 offen offset:3264  lds
    s_add_u32 s24, s24, 4096
    s_mov_b32 m0, s25
    s_add_u32 s25, s25, 4352
    buffer_load_dwordx4 v24, s[40:43], s24 offen offset:0  lds
    buffer_load_dwordx4 v25, s[40:43], s24 offen offset:1088  lds
    buffer_load_dwordx4 v26, s[40:43], s24 offen offset:2176  lds
    buffer_load_dwordx4 v27, s[40:43], s24 offen offset:3264  lds
    s_add_u32 s24, s24, 4096
    s_mov_b32 m0, s25
    s_add_u32 s25, s25, 4352
    buffer_load_dwordx4 v24, s[40:43], s24 offen offset:0  lds
    buffer_load_dwordx4 v25, s[40:43], s24 offen offset:1088  lds
    buffer_load_dwordx4 v26, s[40:43], s24 offen offset:2176  lds
    buffer_load_dwordx4 v27, s[40:43], s24 offen offset:3264  lds
    s_add_u32 s24, s24, 4096
    s_mov_b32 m0, s25
    s_add_u32 s25, s25, 4352
    buffer_load_dwordx4 v24, s[40:43], s24 offen offset:0  lds
    buffer_load_dwordx4 v25, s[40:43], s24 offen offset:1088  lds
    buffer_load_dwordx4 v26, s[40:43], s24 offen offset:2176  lds
    buffer_load_dwordx4 v27, s[40:43], s24 offen offset:3264  lds
    s_lshl_b32 s24, s21, 8
    s_add_u32 s32, s6, s24
    s_addc_u32 s33, s7, 0
    s_and_b32 s33, s33, 0xffff
    s_sub_u32 s76, 134348800, s24
    s_mov_b32 s35, 0x20000
    s_add_u32 s36, s8, s24
    s_addc_u32 s37, s9, 0
    s_and_b32 s37, s37, 0xffff
    s_mov_b32 s39, 0x20000
    v_and_b32 v7, 2, v17
    v_xor_b32 v7, v32, v7
    v_lshlrev_b32 v7, 4, v7
    v_lshl_add_u32 v8, v17, 11, v7
    v_and_b32 v6, 1, v17
    v_lshlrev_b32 v6, 1, v6
    v_xor_b32 v6, v32, v6
    v_lshlrev_b32 v6, 4, v6
    v_lshl_add_u32 v12, v17, 11, v6
    v_add_u32 v9, 7104, v8
    v_add_u32 v13, 7104, v12
    v_add_u32 v10, 14208, v8
    v_add_u32 v14, 14208, v12
    v_add_u32 v11, 21312, v8
    v_add_u32 v15, 21312, v12
    s_mul_i32 s77, s73, 4352
    s_mov_b32 s57, s77
    s_mov_b32 s48, 2
    s_cmp_eq_u32 s23, 0
    s_cselect_b32 s50, 1, -1
    s_mov_b32 s78, 156672
    s_waitcnt vmcnt(16)
    v_readlane_b32 s26, v30, s22
    v_lshlrev_b32 v4, 15, v4
    v_lshlrev_b32 v5, 15, v5
    s_cmp_gt_i32 s26, 0
    s_cselect_b32 s26, s26, 0x1000
    s_min_u32 s26, s26, 0x1000
    s_add_u32 s27, s26, 15
    s_lshr_b32 s27, s27, 4
    s_sub_u32 s52, s26, 1
    s_lshr_b32 s52, s52, 6
    s_mul_i32 s52, s52, s23
    s_mov_b32 s54, 0
    s_and_b32 s24, s52, 63
    v_readlane_b32 s44, v4, s24
    v_readlane_b32 s45, v5, s24
    s_lshl2_add_u32 s24, s52, s73
    s_cmp_lt_u32 s54, s48
    s_cselect_b32 s25, s27, 0
    s_cmp_lt_u32 s24, s25
    s_cselect_b32 s44, s44, 0
    s_cselect_b32 s46, s76, 0
    s_add_u32 s24, s24, 2
    s_cmp_lt_u32 s24, s25
    s_cselect_b32 s45, s45, 0
    s_cselect_b32 s47, s76, 0
    s_add_u32 s52, s52, s50
    s_add_u32 s54, s54, 1
    s_add_u32 s58, s77, 139264
    s_add_u32 m0, s58, 0
    s_mov_b32 s34, s46
    buffer_load_dwordx4 v8, s[32:35], s44 offen offset:0 nt lds
    buffer_load_dwordx4 v9, s[32:35], s44 offen offset:1088 nt lds
    buffer_load_dwordx4 v10, s[32:35], s44 offen offset:2176 nt lds
    buffer_load_dwordx4 v11, s[32:35], s44 offen offset:3264 nt lds
    s_add_u32 m0, s58, 8704
    s_mov_b32 s34, s47
    buffer_load_dwordx4 v8, s[32:35], s45 offen offset:0 nt lds
    buffer_load_dwordx4 v9, s[32:35], s45 offen offset:1088 nt lds
    buffer_load_dwordx4 v10, s[32:35], s45 offen offset:2176 nt lds
    buffer_load_dwordx4 v11, s[32:35], s45 offen offset:3264 nt lds
    s_mov_b32 s55, s44
    s_mov_b32 s56, s45
    s_mov_b32 s74, s46
    s_mov_b32 s75, s47
    s_and_b32 s24, s52, 63
    v_readlane_b32 s44, v4, s24
    v_readlane_b32 s45, v5, s24
    s_lshl2_add_u32 s24, s52, s73
    s_cmp_lt_u32 s54, s48
    s_cselect_b32 s25, s27, 0
    s_cmp_lt_u32 s24, s25
    s_cselect_b32 s44, s44, 0
    s_cselect_b32 s46, s76, 0
    s_add_u32 s24, s24, 2
    s_cmp_lt_u32 s24, s25
    s_cselect_b32 s45, s45, 0
    s_cselect_b32 s47, s76, 0
    s_add_u32 s52, s52, s50
    s_add_u32 s54, s54, 1
    s_add_u32 m0, s57, 0
    s_mov_b32 s34, s46
    s_waitcnt vmcnt(11)
    buffer_load_dwordx4 v8, s[32:35], s44 offen offset:0 nt lds
    s_waitcnt vmcnt(11)
    buffer_load_dwordx4 v9, s[32:35], s44 offen offset:1088 nt lds
    s_waitcnt vmcnt(11)
    buffer_load_dwordx4 v10, s[32:35], s44 offen offset:2176 nt lds
    s_waitcnt vmcnt(11)
    s_barrier
    buffer_load_dwordx4 v11, s[32:35], s44 offen offset:3264 nt lds
    s_add_u32 m0, s57, 17408
    s_mov_b32 s38, s74
    s_waitcnt vmcnt(11)
    buffer_load_dwordx4 v12, s[36:39], s55 offen offset:0 nt lds
    s_waitcnt vmcnt(11)
    buffer_load_dwordx4 v13, s[36:39], s55 offen offset:1088 nt lds
    s_waitcnt vmcnt(11)
    buffer_load_dwordx4 v14, s[36:39], s55 offen offset:2176 nt lds
    s_waitcnt vmcnt(11)
    buffer_load_dwordx4 v15, s[36:39], s55 offen offset:3264 nt lds
    s_add_u32 m0, s57, 8704
    s_mov_b32 s34, s47
    s_waitcnt vmcnt(11)
    buffer_load_dwordx4 v8, s[32:35], s45 offen offset:0 nt lds
    s_waitcnt vmcnt(11)
    buffer_load_dwordx4 v9, s[32:35], s45 offen offset:1088 nt lds
    s_waitcnt vmcnt(11)
    buffer_load_dwordx4 v10, s[32:35], s45 offen offset:2176 nt lds
    s_waitcnt vmcnt(11)
    s_barrier
    buffer_load_dwordx4 v11, s[32:35], s45 offen offset:3264 nt lds
    s_add_u32 m0, s57, 26112
    s_mov_b32 s38, s75
    s_waitcnt vmcnt(11)
    buffer_load_dwordx4 v12, s[36:39], s56 offen offset:0 nt lds
    s_waitcnt vmcnt(11)
    buffer_load_dwordx4 v13, s[36:39], s56 offen offset:1088 nt lds
    s_waitcnt vmcnt(11)
    buffer_load_dwordx4 v14, s[36:39], s56 offen offset:2176 nt lds
    s_waitcnt vmcnt(11)
    buffer_load_dwordx4 v15, s[36:39], s56 offen offset:3264 nt lds
    s_add_u32 s57, s57, 34816
    s_cmp_ge_u32 s57, 104448
    s_cselect_b32 s57, s77, s57
    v_lshlrev_b32 v23, 4, v1
    s_lshl2_add_u32 s24, s73, 156736
    v_add_u32 v3, s24, v23
    ds_read2_b32 v[4:5], v3 offset0:0 offset1:2
    s_mov_b32 s34, s76
    s_mov_b32 s38, s76
    v_lshl_add_u32 v30, v32, 2, s78
    ds_read_b32 v30, v30
    s_lshl3_add_u32 s66, s22, s21
    s_and_b32 s91, s21, 1
    s_lshl_b32 s91, s91, 4
    s_branch L_aux
L_centry:
    s_waitcnt lgkmcnt(0)
    global_load_dword v30, v31, s[12:13]
    s_cmp_lt_u32 s20, 4
    s_cbranch_scc1 L_nobt
    s_mov_b32 s3, 1
    s_cmp_eq_u32 s20, 6
    s_cbranch_scc0 L_setw
    s_lshl_b32 s24, s22, 10
    v_lshl_add_u32 v132, v1, 4, s24
    global_load_dwordx4 v[128:131], v132, s[10:11]
    s_branch L_setw
L_nobt:
    s_mov_b32 s3, 0
    v_lshrrev_b32 v11, 4, v1
    v_and_b32 v12, 3, v1
    v_bfe_u32 v13, v1, 2, 2
    v_mul_u32_u24 v14, 1088, v12
    v_lshl_add_u32 v14, v13, 8, v14
    v_and_b32 v15, 2, v13
    v_xor_b32 v15, v11, v15
    v_lshl_add_u32 v5, v15, 4, v14
    v_mul_u32_u24 v14, 1088, v13
    v_lshl_add_u32 v14, v11, 8, v14
    v_lshl_add_u32 v14, v12, 3, v14
    v_add_u32 v14, 17408, v14
    v_and_b32 v15, 1, v11
    v_lshl_add_u32 v6, v15, 5, v14
    v_xor_b32 v15, 1, v15
    v_lshl_add_u32 v7, v15, 5, v14
    s_lshl_b32 s24, s20, 3
    v_add_u32 v14, s24, v13
    v_mul_u32_u24 v14, 1088, v14
    v_lshl_add_u32 v14, v12, 8, v14
    v_xor_b32 v15, v11, v12
    v_lshl_add_u32 v14, v15, 4, v14
    v_add_u32 v18, 104448, v14
    v_lshrrev_b32 v14, 2, v1
    v_lshlrev_b32 v14, 8, v14
    v_lshl_add_u32 v19, v12, 4, v14
    v_lshlrev_b32 v23, 4, v1
    s_mov_b32 s61, 0x40004000
    v_mov_b32 v8, 0x3f803f80
    v_mov_b32 v9, 0x3f803f80
    v_mov_b32 v10, 0x3f803f80
    v_mov_b32 v11, 0x3f803f80
    s_mov_b32 s28, s18
    s_and_b32 s29, s19, 0xffff
    s_mov_b32 s30, 537395200
    s_mov_b32 s31, 0x20000
    s_mov_b32 s40, s14
    s_and_b32 s41, s15, 0xffff
    s_mov_b32 s42, 4194304
    s_mov_b32 s43, 0x20000
    s_mov_b32 s36, s16
    s_and_b32 s37, s17, 0xffff
    s_mov_b32 s38, 256
    s_mov_b32 s39, 0x20000
    s_mov_b32 s44, s28
    s_mov_b32 s45, s29
    s_mov_b32 s46, s30
    s_mov_b32 s47, 0x20000
    s_getreg_b32 s89, hwreg(HW_REG_XCC_ID, 0, 3)
    s_or_b32 s89, s89, 8
    v_mov_b32 v56, 0
    v_mov_b32 v57, 0
    v_mov_b32 v58, 0
    v_mov_b32 v59, 0
    v_mov_b32 v60, 0
    v_mov_b32 v61, 0
    v_mov_b32 v62, 0
    v_mov_b32 v63, 0
    v_mov_b32 v64, 0
    v_mov_b32 v65, 0
    v_mov_b32 v66, 0
    v_mov_b32 v67, 0
    v_mov_b32 v68, 0
    v_mov_b32 v69, 0
    v_mov_b32 v70, 0
    v_mov_b32 v71, 0
    v_mov_b32 v72, 0
    v_mov_b32 v73, 0
    v_mov_b32 v74, 0
    v_mov_b32 v75, 0
    v_mov_b32 v76, 0
    v_mov_b32 v77, 0
    v_mov_b32 v78, 0
    v_mov_b32 v79, 0
    v_mov_b32 v80, 0
    v_mov_b32 v81, 0
    v_mov_b32 v82, 0
    v_mov_b32 v83, 0
    v_mov_b32 v84, 0
    v_mov_b32 v85, 0
    v_mov_b32 v86, 0
    v_mov_b32 v87, 0
    v_mov_b32 v88, 0
    v_mov_b32 v89, 0
    v_mov_b32 v90, 0
    v_mov_b32 v91, 0
    v_mov_b32 v92, 0
    v_mov_b32 v93, 0
    v_mov_b32 v94, 0
    v_mov_b32 v95, 0
    v_mov_b32 v96, 0
    v_mov_b32 v97, 0
    v_mov_b32 v98, 0
    v_mov_b32 v99, 0
    v_mov_b32 v100, 0
    v_mov_b32 v101, 0
    v_mov_b32 v102, 0
    v_mov_b32 v103, 0
    v_mov_b32 v104, 0
    v_mov_b32 v105, 0
    v_mov_b32 v106, 0
    v_mov_b32 v107, 0
    v_mov_b32 v108, 0
    v_mov_b32 v109, 0
    v_mov_b32 v110, 0
    v_mov_b32 v111, 0
    v_mov_b32 v112, 0
    v_mov_b32 v113, 0
    v_mov_b32 v114, 0
    v_mov_b32 v115, 0
    v_mov_b32 v116, 0
    v_mov_b32 v117, 0
    v_mov_b32 v118, 0
    v_mov_b32 v119, 0
    v_mov_b32 v120, 0
    v_mov_b32 v121, 0
    v_mov_b32 v122, 0
    v_mov_b32 v123, 0
    v_mov_b32 v124, 0
    v_mov_b32 v125, 0
    v_mov_b32 v126, 0
    v_mov_b32 v127, 0
    v_mov_b32 v176, 0
    v_mov_b32 v177, 0
    v_mov_b32 v178, 0
    v_mov_b32 v179, 0
    v_mov_b32 v180, 0
    v_mov_b32 v181, 0
    v_mov_b32 v182, 0
    v_mov_b32 v183, 0
L_setw:
    s_waitcnt vmcnt(0)
L_setup:
    v_cmp_lt_i32 vcc, 0, v30
    v_mov_b32 v31, 0x1000
    v_mov_b32 v34, 0
    v_cndmask_b32 v30, v31, v30, vcc
    s_mov_b32 s68, vcc_lo
    v_min_u32 v30, v30, v31
    v_lshl_add_u32 v32, v30, 4, v32
    v_add_u32 v31, 63, v30
    v_lshrrev_b32 v31, 6, v31
    v_sub_u32_dpp v33, v32, v32 row_ror:1 row_mask:0xf bank_mask:0xf
    v_alignbit_b32 v34, v34, v33, 31
    v_sub_u32_dpp v33, v32, v32 row_ror:2 row_mask:0xf bank_mask:0xf
    v_alignbit_b32 v34, v34, v33, 31
    v_add_u32_dpp v35, v31, v31 row_ror:8 row_mask:0xf bank_mask:0xf
    v_sub_u32_dpp v33, v32, v32 row_ror:3 row_mask:0xf bank_mask:0xf
    v_alignbit_b32 v34, v34, v33, 31
    v_sub_u32_dpp v33, v32, v32 row_ror:4 row_mask:0xf bank_mask:0xf
    v_alignbit_b32 v34, v34, v33, 31
    v_add_u32_dpp v35, v35, v35 row_ror:4 row_mask:0xf bank_mask:0xf
    v_sub_u32_dpp v33, v32, v32 row_ror:5 row_mask:0xf bank_mask:0xf
    v_alignbit_b32 v34, v34, v33, 31
    v_sub_u32_dpp v33, v32, v32 row_ror:6 row_mask:0xf bank_mask:0xf
    v_alignbit_b32 v34, v34, v33, 31
    v_add_u32_dpp v35, v35, v35 row_ror:2 row_mask:0xf bank_mask:0xf
    v_sub_u32_dpp v33, v32, v32 row_ror:7 row_mask:0xf bank_mask:0xf
    v_alignbit_b32 v34, v34, v33, 31
    v_sub_u32_dpp v33, v32, v32 row_ror:8 row_mask:0xf bank_mask:0xf
    v_alignbit_b32 v34, v34, v33, 31
    v_add_u32_dpp v35, v35, v35 row_ror:1 row_mask:0xf bank_mask:0xf
    v_sub_u32_dpp v33, v32, v32 row_ror:9 row_mask:0xf bank_mask:0xf
    v_alignbit_b32 v34, v34, v33, 31
    v_sub_u32_dpp v33, v32, v32 row_ror:10 row_mask:0xf bank_mask:0xf
    v_alignbit_b32 v34, v34, v33, 31
    v_sub_u32_dpp v33, v32, v32 row_ror:11 row_mask:0xf bank_mask:0xf
    v_alignbit_b32 v34, v34, v33, 31
    v_sub_u32_dpp v33, v32, v32 row_ror:12 row_mask:0xf bank_mask:0xf
    v_alignbit_b32 v34, v34, v33, 31
    v_sub_u32_dpp v33, v32, v32 row_ror:13 row_mask:0xf bank_mask:0xf
    v_alignbit_b32 v34, v34, v33, 31
    v_sub_u32_dpp v33, v32, v32 row_ror:14 row_mask:0xf bank_mask:0xf
    v_alignbit_b32 v34, v34, v33, 31
    v_sub_u32_dpp v33, v32, v32 row_ror:15 row_mask:0xf bank_mask:0xf
    v_alignbit_b32 v34, v34, v33, 31
    v_bcnt_u32_b32 v34, v34, 0
    v_readlane_b32 s26, v30, s22
    v_readlane_b32 s53, v31, s22
    v_readlane_b32 s69, v34, s22
    v_readlane_b32 s90, v35, 0
    s_sub_u32 s24, 15, s69
    v_cmp_eq_u32 vcc, s24, v34
    s_bitcmp1_b32 s68, s22
    s_cselect_b32 s60, 0x3e0293ee, 0
    s_ff1_i32_b32 s86, vcc_lo
    v_readlane_b32 s70, v31, s86
    v_readlane_b32 s87, v30, s86
    s_bitcmp1_b32 s68, s86
    s_cselect_b32 s88, 0x3e0293ee, 0
    s_add_u32 s27, s26, 15
    s_lshr_b32 s27, s27, 4
    s_lshl3_add_u32 s66, s22, s21
    s_cmp_ge_u32 s69, 8
    s_cselect_b32 s71, s53, s70
    s_cselect_b32 s72, s70, s53
    s_mul_i32 s24, s72, 3
    s_sub_i32 s24, s24, s71
    s_lshl_b32 s24, s24, 1
    s_sub_i32 s24, s24, 10
    s_ashr_i32 s24, s24, 3
    s_max_i32 s78, s24, 1
    s_lshl_b32 s24, s78, 1
    s_sub_i32 s24, s71, s24
    s_sub_i32 s24, s24, 7
    s_max_i32 s24, s24, 0
    s_mul_i32 s24, s24, 0x5556
    s_lshr_b32 s84, s24, 16
    s_lshr_b32 s24, s6, 8
    s_add_u32 s24, s24, s21
    s_and_b32 s24, s24, 3
    s_cmp_eq_u32 s24, 1
    s_cselect_b32 s24, 36, 45
    s_mul_i32 s24, s24, s90
    s_lshl_b32 s25, s71, 9
    s_cmp_gt_u32 s25, s24
    s_cselect_b32 s84, s84, 0
    s_cmp_ge_u32 s72, 2
    s_cselect_b32 s84, s84, 0
    s_cmp_ge_u32 s84, 3
    s_cselect_b32 s84, s84, 0
    s_mov_b32 s83, s84
    s_sub_u32 s24, s71, s84
    s_sub_i32 s24, s24, 2
    s_lshr_b32 s85, s24, 1
    s_sub_i32 s24, s53, 2
    s_max_i32 s24, s24, 0
    s_lshr_b32 s24, s24, 1
    s_mov_b32 s25, 0
    s_cmp_eq_u32 s24, 0
    s_cselect_b32 s51, 1, 2
    s_cmp_eq_u32 s84, 0
    s_cbranch_scc1 L_set2
    s_cmp_ge_u32 s69, 8
    s_cselect_b32 s24, s85, s78
    s_cselect_b32 s25, s84, 0
    s_cselect_b32 s51, 3, 2
    s_cselect_b32 s84, 0, s84
L_set2:
    s_mov_b32 s32, s24
    s_mov_b32 s34, s25
    s_add_u32 s35, s78, 3
    s_sub_u32 s25, s53, s25
    s_sub_u32 s25, s25, s24
    s_mov_b32 s33, s25
    s_sub_u32 s49, s53, 1
    s_cmp_eq_u32 s23, 0
    s_cselect_b32 s48, s24, s25
    s_cselect_b32 s49, 0, s49
    s_cselect_b32 s50, 1, -1
    s_cselect_b32 s84, s84, 0
    s_and_b32 s91, s21, 1
    s_lshl_b32 s91, s91, 4
    s_cmp_eq_u32 s3, 1
    s_cbranch_scc1 L_order
    s_cmp_eq_u32 s48, 0
    s_cbranch_scc1 L_end
    s_mov_b32 s63, 0
    s_cmp_eq_u32 s23, 1
    s_cselect_b32 s52, s51, 1
    s_cmp_eq_u32 s20, 0
    s_cselect_b32 s52, s52, 1
    s_cmp_gt_u32 s52, 1
    s_cselect_b32 s52, 1, 0
    s_cbranch_scc0 L_cseg
    v_mov_b32 v12, 0
    v_lshlrev_b32 v13, 2, v1
    s_lshl_b32 s24, s66, 7
    s_add_u32 s24, s24, 33554432
    s_mov_b64 exec, 0xff
    buffer_store_dword v12, v13, s[28:31], s24 offen
    s_mov_b64 exec, -1
L_cseg:
    v_add_u32 v2, 139264, v5
    v_add_u32 v3, s63, v6
    v_add_u32 v4, s63, v7
    s_lshl_b32 s24, s49, 6
    s_sub_u32 s54, s26, s24
    v_lshrrev_b32 v216, 4, v1
    v_sub_u32 v216, s54, v216
    v_mov_b32 v217, 0xff800000
    v_mov_b32 v218, s60
    s_lshr_b32 s57, s66, 1
    s_lshl_b32 s57, s57, 2
    v_mov_b32 v220, 0
    s_lshl_b32 s25, s20, 13
    s_lshl_b32 s59, s66, 15
    s_add_u32 s59, s59, s25
    s_lshr_b32 s24, s23, 1
    s_lshl1_add_u32 s24, s66, s24
    s_mul_i32 s55, s24, 36864
    s_add_u32 s56, s55, s25
    s_cmp_eq_u32 s23, 0
    s_cselect_b32 s44, s40, s28
    s_cselect_b32 s45, s41, s29
    s_cselect_b32 s46, s42, s30
    s_cselect_b32 s56, s59, s56
    s_barrier
    ds_read_b128 v[24:27], v18 offset:0
    ds_read_b128 v[28:31], v18 offset:64
    ds_read_b128 v[32:35], v18 offset:128
    ds_read_b128 v[36:39], v18 offset:192
    ds_read_b128 v[40:43], v18 offset:4352
    ds_read_b128 v[44:47], v18 offset:4416
    ds_read_b128 v[48:51], v18 offset:4480
    ds_read_b128 v[52:55], v18 offset:4544
    s_waitcnt lgkmcnt(7)
    v_lshlrev_b32 v12, 16, v24
    v_and_b32 v13, 0xffff0000, v24
    v_pk_mul_f32 v[12:13], v[12:13], v[218:219] op_sel_hi:[1,0]
    v_cvt_pk_bf16_f32 v24, v12, v13
    v_lshlrev_b32 v14, 16, v25
    v_and_b32 v15, 0xffff0000, v25
    v_pk_mul_f32 v[14:15], v[14:15], v[218:219] op_sel_hi:[1,0]
    v_cvt_pk_bf16_f32 v25, v14, v15
    v_lshlrev_b32 v16, 16, v26
    v_and_b32 v17, 0xffff0000, v26
    v_pk_mul_f32 v[16:17], v[16:17], v[218:219] op_sel_hi:[1,0]
    v_cvt_pk_bf16_f32 v26, v16, v17
    v_lshlrev_b32 v12, 16, v27
    v_and_b32 v13, 0xffff0000, v27
    v_pk_mul_f32 v[12:13], v[12:13], v[218:219] op_sel_hi:[1,0]
    v_cvt_pk_bf16_f32 v27, v12, v13
    s_waitcnt lgkmcnt(6)
    v_lshlrev_b32 v12, 16, v28
    v_and_b32 v13, 0xffff0000, v28
    v_pk_mul_f32 v[12:13], v[12:13], v[218:219] op_sel_hi:[1,0]
    v_cvt_pk_bf16_f32 v28, v12, v13
    v_lshlrev_b32 v14, 16, v29
    v_and_b32 v15, 0xffff0000, v29
    v_pk_mul_f32 v[14:15], v[14:15], v[218:219] op_sel_hi:[1,0]
    v_cvt_pk_bf16_f32 v29, v14, v15
    v_lshlrev_b32 v16, 16, v30
    v_and_b32 v17, 0xffff0000, v30
    v_pk_mul_f32 v[16:17], v[16:17], v[218:219] op_sel_hi:[1,0]
    v_cvt_pk_bf16_f32 v30, v16, v17
    v_lshlrev_b32 v12, 16, v31
    v_and_b32 v13, 0xffff0000, v31
    v_pk_mul_f32 v[12:13], v[12:13], v[218:219] op_sel_hi:[1,0]
    v_cvt_pk_bf16_f32 v31, v12, v13
    s_waitcnt lgkmcnt(5)
    v_lshlrev_b32 v12, 16, v32
    v_and_b32 v13, 0xffff0000, v32
    v_pk_mul_f32 v[12:13], v[12:13], v[218:219] op_sel_hi:[1,0]
    v_cvt_pk_bf16_f32 v32, v12, v13
    v_lshlrev_b32 v14, 16, v33
    v_and_b32 v15, 0xffff0000, v33
    v_pk_mul_f32 v[14:15], v[14:15], v[218:219] op_sel_hi:[1,0]
    v_cvt_pk_bf16_f32 v33, v14, v15
    v_lshlrev_b32 v16, 16, v34
    v_and_b32 v17, 0xffff0000, v34
    v_pk_mul_f32 v[16:17], v[16:17], v[218:219] op_sel_hi:[1,0]
    v_cvt_pk_bf16_f32 v34, v16, v17
    v_lshlrev_b32 v12, 16, v35
    v_and_b32 v13, 0xffff0000, v35
    v_pk_mul_f32 v[12:13], v[12:13], v[218:219] op_sel_hi:[1,0]
    v_cvt_pk_bf16_f32 v35, v12, v13
    s_waitcnt lgkmcnt(4)
    v_lshlrev_b32 v12, 16, v36
    v_and_b32 v13, 0xffff0000, v36
    v_pk_mul_f32 v[12:13], v[12:13], v[218:219] op_sel_hi:[1,0]
    v_cvt_pk_bf16_f32 v36, v12, v13
    v_lshlrev_b32 v14, 16, v37
    v_and_b32 v15, 0xffff0000, v37
    v_pk_mul_f32 v[14:15], v[14:15], v[218:219] op_sel_hi:[1,0]
    v_cvt_pk_bf16_f32 v37, v14, v15
    v_lshlrev_b32 v16, 16, v38
    v_and_b32 v17, 0xffff0000, v38
    v_pk_mul_f32 v[16:17], v[16:17], v[218:219] op_sel_hi:[1,0]
    v_cvt_pk_bf16_f32 v38, v16, v17
    v_lshlrev_b32 v12, 16, v39
    v_and_b32 v13, 0xffff0000, v39
    v_pk_mul_f32 v[12:13], v[12:13], v[218:219] op_sel_hi:[1,0]
    v_cvt_pk_bf16_f32 v39, v12, v13
    s_waitcnt lgkmcnt(3)
    v_lshlrev_b32 v12, 16, v40
    v_and_b32 v13, 0xffff0000, v40
    v_pk_mul_f32 v[12:13], v[12:13], v[218:219] op_sel_hi:[1,0]
    v_cvt_pk_bf16_f32 v40, v12, v13
    v_lshlrev_b32 v14, 16, v41
    v_and_b32 v15, 0xffff0000, v41
    v_pk_mul_f32 v[14:15], v[14:15], v[218:219] op_sel_hi:[1,0]
    v_cvt_pk_bf16_f32 v41, v14, v15
    v_lshlrev_b32 v16, 16, v42
    v_and_b32 v17, 0xffff0000, v42
    v_pk_mul_f32 v[16:17], v[16:17], v[218:219] op_sel_hi:[1,0]
    v_cvt_pk_bf16_f32 v42, v16, v17
    v_lshlrev_b32 v12, 16, v43
    v_and_b32 v13, 0xffff0000, v43
    v_pk_mul_f32 v[12:13], v[12:13], v[218:219] op_sel_hi:[1,0]
    v_cvt_pk_bf16_f32 v43, v12, v13
    s_waitcnt lgkmcnt(2)
    v_lshlrev_b32 v12, 16, v44
    v_and_b32 v13, 0xffff0000, v44
    v_pk_mul_f32 v[12:13], v[12:13], v[218:219] op_sel_hi:[1,0]
    v_cvt_pk_bf16_f32 v44, v12, v13
    v_lshlrev_b32 v14, 16, v45
    v_and_b32 v15, 0xffff0000, v45
    v_pk_mul_f32 v[14:15], v[14:15], v[218:219] op_sel_hi:[1,0]
    v_cvt_pk_bf16_f32 v45, v14, v15
    v_lshlrev_b32 v16, 16, v46
    v_and_b32 v17, 0xffff0000, v46
    v_pk_mul_f32 v[16:17], v[16:17], v[218:219] op_sel_hi:[1,0]
    v_cvt_pk_bf16_f32 v46, v16, v17
    v_lshlrev_b32 v12, 16, v47
    v_and_b32 v13, 0xffff0000, v47
    v_pk_mul_f32 v[12:13], v[12:13], v[218:219] op_sel_hi:[1,0]
    v_cvt_pk_bf16_f32 v47, v12, v13
    s_waitcnt lgkmcnt(1)
    v_lshlrev_b32 v12, 16, v48
    v_and_b32 v13, 0xffff0000, v48
    v_pk_mul_f32 v[12:13], v[12:13], v[218:219] op_sel_hi:[1,0]
    v_cvt_pk_bf16_f32 v48, v12, v13
    v_lshlrev_b32 v14, 16, v49
    v_and_b32 v15, 0xffff0000, v49
    v_pk_mul_f32 v[14:15], v[14:15], v[218:219] op_sel_hi:[1,0]
    v_cvt_pk_bf16_f32 v49, v14, v15
    v_lshlrev_b32 v16, 16, v50
    v_and_b32 v17, 0xffff0000, v50
    v_pk_mul_f32 v[16:17], v[16:17], v[218:219] op_sel_hi:[1,0]
    v_cvt_pk_bf16_f32 v50, v16, v17
    v_lshlrev_b32 v12, 16, v51
    v_and_b32 v13, 0xffff0000, v51
    v_pk_mul_f32 v[12:13], v[12:13], v[218:219] op_sel_hi:[1,0]
    v_cvt_pk_bf16_f32 v51, v12, v13
    s_waitcnt lgkmcnt(0)
    v_lshlrev_b32 v12, 16, v52
    v_and_b32 v13, 0xffff0000, v52
    v_pk_mul_f32 v[12:13], v[12:13], v[218:219] op_sel_hi:[1,0]
    v_cvt_pk_bf16_f32 v52, v12, v13
    v_lshlrev_b32 v14, 16, v53
    v_and_b32 v15, 0xffff0000, v53
    v_pk_mul_f32 v[14:15], v[14:15], v[218:219] op_sel_hi:[1,0]
    v_cvt_pk_bf16_f32 v53, v14, v15
    v_lshlrev_b32 v16, 16, v54
    v_and_b32 v17, 0xffff0000, v54
    v_pk_mul_f32 v[16:17], v[16:17], v[218:219] op_sel_hi:[1,0]
    v_cvt_pk_bf16_f32 v54, v16, v17
    v_lshlrev_b32 v12, 16, v55
    v_and_b32 v13, 0xffff0000, v55
    v_pk_mul_f32 v[12:13], v[12:13], v[218:219] op_sel_hi:[1,0]
    v_cvt_pk_bf16_f32 v55, v12, v13
    s_waitcnt vmcnt(0)
    s_cmp_eq_u32 s52, 1
    s_cbranch_scc1 L_ann
L_annr:
    s_barrier
    ds_read_b128 v[184:187], v2 offset:0
    ds_read_b128 v[188:191], v2 offset:64
    ds_read_b128 v[192:195], v2 offset:128
    ds_read_b128 v[196:199], v2 offset:192
    ds_read_b128 v[200:203], v2 offset:4352
    ds_read_b128 v[204:207], v2 offset:4416
    ds_read_b128 v[208:211], v2 offset:4480
    ds_read_b128 v[212:215], v2 offset:4544
    s_waitcnt lgkmcnt(7)
    v_mfma_f32_16x16x32_bf16 v[128:131], v[184:187], v[24:27], 0
    v_mfma_f32_16x16x32_bf16 v[132:135], v[184:187], v[40:43], 0
    ds_read_b128 v[224:227], v2 offset:8704
    s_waitcnt lgkmcnt(7)
    v_mfma_f32_16x16x32_bf16 v[128:131], v[188:191], v[28:31], v[128:131]
    v_mfma_f32_16x16x32_bf16 v[132:135], v[188:191], v[44:47], v[132:135]
    ds_read_b128 v[228:231], v2 offset:8768
    s_waitcnt lgkmcnt(7)
    v_mfma_f32_16x16x32_bf16 v[128:131], v[192:195], v[32:35], v[128:131]
    v_mfma_f32_16x16x32_bf16 v[132:135], v[192:195], v[48:51], v[132:135]
    ds_read_b128 v[232:235], v2 offset:8832
    s_waitcnt lgkmcnt(7)
    v_mfma_f32_16x16x32_bf16 v[128:131], v[196:199], v[36:39], v[128:131]
    v_mfma_f32_16x16x32_bf16 v[132:135], v[196:199], v[52:55], v[132:135]
    ds_read_b128 v[236:239], v2 offset:8896
    s_waitcnt lgkmcnt(7)
    v_mfma_f32_16x16x32_bf16 v[136:139], v[200:203], v[24:27], 0
    v_mfma_f32_16x16x32_bf16 v[140:143], v[200:203], v[40:43], 0
    ds_read_b128 v[240:243], v2 offset:13056
    s_waitcnt lgkmcnt(7)
    v_mfma_f32_16x16x32_bf16 v[136:139], v[204:207], v[28:31], v[136:139]
    v_mfma_f32_16x16x32_bf16 v[140:143], v[204:207], v[44:47], v[140:143]
    ds_read_b128 v[244:247], v2 offset:13120
    s_waitcnt lgkmcnt(7)
    v_mfma_f32_16x16x32_bf16 v[136:139], v[208:211], v[32:35], v[136:139]
    v_mfma_f32_16x16x32_bf16 v[140:143], v[208:211], v[48:51], v[140:143]
    ds_read_b128 v[248:251], v2 offset:13184
    s_waitcnt lgkmcnt(7)
    v_mfma_f32_16x16x32_bf16 v[136:139], v[212:215], v[36:39], v[136:139]
    v_mfma_f32_16x16x32_bf16 v[140:143], v[212:215], v[52:55], v[140:143]
    ds_read_b128 v[252:255], v2 offset:13248
    s_waitcnt lgkmcnt(7)
    v_mfma_f32_16x16x32_bf16 v[144:147], v[224:227], v[24:27], 0
    v_mov_b32 v200, 0
    v_mov_b32 v201, 0
    v_mov_b32 v202, 0
    v_mov_b32 v203, 0
    v_mfma_f32_16x16x32_bf16 v[148:151], v[224:227], v[40:43], 0
    v_mov_b32 v204, 0
    v_mov_b32 v205, 0
    v_mov_b32 v206, 0
    v_mov_b32 v207, 0
    s_waitcnt lgkmcnt(6)
    v_mfma_f32_16x16x32_bf16 v[144:147], v[228:231], v[28:31], v[144:147]
    v_mov_b32 v208, 0
    v_mov_b32 v209, 0
    v_mov_b32 v210, 0
    v_mov_b32 v211, 0
    v_mfma_f32_16x16x32_bf16 v[148:151], v[228:231], v[44:47], v[148:151]
    v_mov_b32 v212, 0
    v_mov_b32 v213, 0
    v_mov_b32 v214, 0
    v_mov_b32 v215, 0
    s_cmp_lt_u32 s54, 32
    s_cbranch_scc1 L_mask0
L_maskr0:
    s_waitcnt lgkmcnt(5)
    v_mfma_f32_16x16x32_bf16 v[144:147], v[232:235], v[32:35], v[144:147]
    v_max3_f32 v12, v128, v129, v130
    v_max3_f32 v12, v12, v131, v136
    v_max3_f32 v12, v12, v137, v138
    v_mfma_f32_16x16x32_bf16 v[148:151], v[232:235], v[48:51], v[148:151]
    v_max_f32 v12, v12, v139
    v_max3_f32 v13, v132, v133, v134
    v_max3_f32 v13, v13, v135, v140
    v_max3_f32 v13, v13, v141, v142
    s_waitcnt lgkmcnt(4)
    v_mfma_f32_16x16x32_bf16 v[144:147], v[236:239], v[36:39], v[144:147]
    v_max_f32 v13, v13, v143
    v_mov_b32 v14, v12
    v_mov_b32 v15, v13
    s_nop 0
    v_mfma_f32_16x16x32_bf16 v[148:151], v[236:239], v[52:55], v[148:151]
    v_permlane32_swap_b32 v12, v14
    v_permlane32_swap_b32 v13, v15
    v_max_f32 v12, v12, v14
    v_max_f32 v13, v13, v15
    s_waitcnt lgkmcnt(3)
    v_mfma_f32_16x16x32_bf16 v[152:155], v[240:243], v[24:27], 0
    v_mov_b32 v14, v12
    v_mov_b32 v15, v13
    s_nop 0
    v_permlane16_swap_b32 v12, v14
    v_mfma_f32_16x16x32_bf16 v[156:159], v[240:243], v[40:43], 0
    v_permlane16_swap_b32 v13, v15
    v_max_f32 v12, v12, v14
    v_max_f32 v13, v13, v15
    v_sub_f32 v160, 0xc1200000, v12
    s_waitcnt lgkmcnt(2)
    v_mfma_f32_16x16x32_bf16 v[152:155], v[244:247], v[28:31], v[152:155]
    v_sub_f32 v161, 0xc1200000, v12
    v_sub_f32 v162, 0xc1200000, v12
    v_sub_f32 v163, 0xc1200000, v12
    v_mfma_f32_16x16x32_bf16 v[156:159], v[244:247], v[44:47], v[156:159]
    v_sub_f32 v164, 0xc1200000, v13
    v_sub_f32 v165, 0xc1200000, v13
    v_sub_f32 v166, 0xc1200000, v13
    v_sub_f32 v167, 0xc1200000, v13
    s_waitcnt lgkmcnt(1)
    v_mfma_f32_16x16x32_bf16 v[152:155], v[248:251], v[32:35], v[152:155]
    v_add_f32 v128, v128, v160
    v_add_f32 v129, v129, v160
    v_add_f32 v130, v130, v160
    v_add_f32 v131, v131, v160
    v_mfma_f32_16x16x32_bf16 v[156:159], v[248:251], v[48:51], v[156:159]
    v_add_f32 v132, v132, v164
    v_add_f32 v133, v133, v164
    v_add_f32 v134, v134, v164
    v_add_f32 v135, v135, v164
    s_waitcnt lgkmcnt(0)
    v_mfma_f32_16x16x32_bf16 v[152:155], v[252:255], v[36:39], v[152:155]
    v_add_f32 v136, v136, v160
    v_add_f32 v137, v137, v160
    v_add_f32 v138, v138, v160
    v_add_f32 v139, v139, v160
    v_mfma_f32_16x16x32_bf16 v[156:159], v[252:255], v[52:55], v[156:159]
    v_add_f32 v140, v140, v164
    v_add_f32 v141, v141, v164
    v_add_f32 v142, v142, v164
    v_add_f32 v143, v143, v164
    v_add_u32 v2, s63, v5
    v_exp_f32 v12, v128
    v_exp_f32 v13, v129
    s_nop 0
    v_cvt_pk_bf16_f32 v168, v12, v13
    v_exp_f32 v14, v130
    v_exp_f32 v15, v131
    v_exp_f32 v16, v132
    s_nop 0
    v_cvt_pk_bf16_f32 v169, v14, v15
    v_exp_f32 v17, v133
    s_nop 0
    v_cvt_pk_bf16_f32 v172, v16, v17
    v_exp_f32 v12, v134
    v_or3_b32 v0, v168, v169, v172
    v_exp_f32 v13, v135
    s_nop 0
    v_cvt_pk_bf16_f32 v173, v12, v13
    v_exp_f32 v14, v136
    v_exp_f32 v15, v137
    s_nop 0
    v_cvt_pk_bf16_f32 v170, v14, v15
    v_exp_f32 v16, v138
    v_or3_b32 v0, v0, v173, v170
    v_exp_f32 v17, v139
    v_exp_f32 v12, v140
    v_exp_f32 v13, v141
    s_cmp_lt_u32 s54, 64
    s_cbranch_scc1 L_mask1
L_maskr1:
    v_add_f32 v144, v144, v160
    v_add_f32 v145, v145, v160
    v_add_f32 v146, v146, v160
    v_add_f32 v147, v147, v160
    v_add_f32 v148, v148, v164
    v_add_f32 v149, v149, v164
    v_add_f32 v150, v150, v164
    v_add_f32 v151, v151, v164
    v_add_f32 v152, v152, v160
    v_add_f32 v153, v153, v160
    v_add_f32 v154, v154, v160
    v_add_f32 v155, v155, v160
    v_add_f32 v156, v156, v164
    v_add_f32 v157, v157, v164
    v_add_f32 v158, v158, v164
    v_add_f32 v159, v159, v164
    s_sub_u32 s62, s48, 1
    s_cmp_gt_u32 s62, 4
    s_cselect_b32 s68, 4, 0
    s_cmp_eq_u32 s23, 1
    s_cselect_b32 s68, 0, s68
    s_sub_u32 s62, s62, s68
    s_mov_b32 s69, s68
    s_barrier
    s_sub_u32 s62, s62, 1
    s_cbranch_scc1 L_epi
.p2align 6
L_loop:
    ds_read_b128 v[184:187], v2 offset:0
    s_waitcnt lgkmcnt(5)
    v_mfma_f32_16x16x32_bf16 v[152:155], v[200:203], v[36:39], v[152:155]
    v_exp_f32 v14, v142
    v_mfma_f32_16x16x32_bf16 v[156:159], v[200:203], v[52:55], v[156:159]
    ds_read_b128 v[188:191], v2 offset:64
    v_cvt_pk_bf16_f32 v171, v16, v17
    v_mfma_f32_16x16x32_bf16 v[96:99], v[204:207], v[176:179], v[96:99]
    v_exp_f32 v15, v143
    v_mfma_f32_16x16x32_bf16 v[100:103], v[204:207], v[180:183], v[100:103]
    ds_read_b128 v[192:195], v2 offset:128
    s_waitcnt lgkmcnt(3)
    v_mfma_f32_16x16x32_bf16 v[104:107], v[208:211], v[176:179], v[104:107]
    v_cvt_pk_bf16_f32 v174, v12, v13
    v_or3_b32 v0, v0, v171, v174
    v_cvt_pk_bf16_f32 v175, v14, v15
    v_mfma_f32_16x16x32_bf16 v[108:111], v[208:211], v[180:183], v[108:111]
    ds_read_b64_tr_b16 v[196:197], v3 offset:0
    ds_read_b64_tr_b16 v[198:199], v3 offset:4352
    v_mfma_f32_16x16x32_bf16 v[112:115], v[212:215], v[176:179], v[112:115]
    v_bitop3_b32 v0, v0, v175, s61 bitop3:0xa8
    v_cmp_ne_u32 vcc, 0, v0
    v_mfma_f32_16x16x32_bf16 v[116:119], v[212:215], v[180:183], v[116:119]
    ds_read_b128 v[200:203], v2 offset:192
    s_cbranch_vccnz L_fbs1
L_fbr1:
    s_waitcnt lgkmcnt(4)
    v_mfma_f32_16x16x32_bf16 v[128:131], v[184:187], v[24:27], v[160:163]
    v_exp_f32 v12, v144
    v_mfma_f32_16x16x32_bf16 v[132:135], v[184:187], v[40:43], v[164:167]
    ds_read_b64_tr_b16 v[204:205], v4 offset:0
    ds_read_b64_tr_b16 v[206:207], v4 offset:4352
    v_mfma_f32_16x16x32_bf16 v[128:131], v[188:191], v[28:31], v[128:131]
    v_exp_f32 v13, v145
    v_mfma_f32_16x16x32_bf16 v[132:135], v[188:191], v[44:47], v[132:135]
    ds_read_b128 v[208:211], v2 offset:4352
    v_cvt_pk_bf16_f32 v176, v12, v13
    s_waitcnt lgkmcnt(4)
    v_mfma_f32_16x16x32_bf16 v[128:131], v[192:195], v[32:35], v[128:131]
    v_exp_f32 v14, v146
    v_mfma_f32_16x16x32_bf16 v[132:135], v[192:195], v[48:51], v[132:135]
    ds_read_b64_tr_b16 v[212:213], v3 offset:64
    ds_read_b64_tr_b16 v[214:215], v3 offset:4416
    s_add_u32 s63, s63, 34816
    v_mfma_f32_16x16x32_bf16 v[120:123], v[8:11], v[168:171], v[120:123]
    v_exp_f32 v15, v147
    v_mfma_f32_16x16x32_bf16 v[124:127], v[8:11], v[172:175], v[124:127]
    v_exp_f32 v16, v148
    v_cvt_pk_bf16_f32 v177, v14, v15
    v_mfma_f32_16x16x32_bf16 v[56:59], v[196:199], v[168:171], v[56:59]
    v_exp_f32 v17, v149
    v_mfma_f32_16x16x32_bf16 v[60:63], v[196:199], v[172:175], v[60:63]
    ds_read_b128 v[184:187], v2 offset:4416
    v_cvt_pk_bf16_f32 v180, v16, v17
    s_waitcnt lgkmcnt(4)
    v_mfma_f32_16x16x32_bf16 v[128:131], v[200:203], v[36:39], v[128:131]
    v_exp_f32 v12, v150
    v_or3_b32 v0, v176, v177, v180
    v_mfma_f32_16x16x32_bf16 v[132:135], v[200:203], v[52:55], v[132:135]
    ds_read_b64_tr_b16 v[188:189], v4 offset:64
    ds_read_b64_tr_b16 v[190:191], v4 offset:4416
    s_cmp_eq_u32 s63, 104448
    s_cselect_b32 s63, 0, s63
    v_mfma_f32_16x16x32_bf16 v[64:67], v[204:207], v[168:171], v[64:67]
    v_exp_f32 v13, v151
    v_mfma_f32_16x16x32_bf16 v[68:71], v[204:207], v[172:175], v[68:71]
    ds_read_b128 v[192:195], v2 offset:4480
    v_cvt_pk_bf16_f32 v181, v12, v13
    s_waitcnt lgkmcnt(4)
    v_mfma_f32_16x16x32_bf16 v[136:139], v[208:211], v[24:27], v[160:163]
    v_exp_f32 v14, v152
    v_mfma_f32_16x16x32_bf16 v[140:143], v[208:211], v[40:43], v[164:167]
    ds_read_b64_tr_b16 v[196:197], v3 offset:128
    ds_read_b64_tr_b16 v[198:199], v3 offset:4480
    v_mfma_f32_16x16x32_bf16 v[72:75], v[212:215], v[168:171], v[72:75]
    v_exp_f32 v15, v153
    v_mfma_f32_16x16x32_bf16 v[76:79], v[212:215], v[172:175], v[76:79]
    ds_read_b128 v[200:203], v2 offset:4544
    v_cvt_pk_bf16_f32 v178, v14, v15
    s_waitcnt lgkmcnt(4)
    v_mfma_f32_16x16x32_bf16 v[136:139], v[184:187], v[28:31], v[136:139]
    v_exp_f32 v16, v154
    v_or3_b32 v0, v0, v181, v178
    v_mfma_f32_16x16x32_bf16 v[140:143], v[184:187], v[44:47], v[140:143]
    ds_read_b64_tr_b16 v[204:205], v4 offset:128
    ds_read_b64_tr_b16 v[206:207], v4 offset:4480
    v_mfma_f32_16x16x32_bf16 v[80:83], v[188:191], v[168:171], v[80:83]
    v_exp_f32 v17, v155
    v_mfma_f32_16x16x32_bf16 v[84:87], v[188:191], v[172:175], v[84:87]
    ds_read_b64_tr_b16 v[208:209], v3 offset:192
    ds_read_b64_tr_b16 v[210:211], v3 offset:4544
    s_waitcnt lgkmcnt(5)
    v_mfma_f32_16x16x32_bf16 v[136:139], v[192:195], v[32:35], v[136:139]
    v_exp_f32 v12, v156
    v_mfma_f32_16x16x32_bf16 v[140:143], v[192:195], v[48:51], v[140:143]
    ds_read_b64_tr_b16 v[212:213], v4 offset:192
    ds_read_b64_tr_b16 v[214:215], v4 offset:4544
    v_mfma_f32_16x16x32_bf16 v[88:91], v[196:199], v[168:171], v[88:91]
    v_exp_f32 v13, v157
    v_mfma_f32_16x16x32_bf16 v[92:95], v[196:199], v[172:175], v[92:95]
    s_barrier
    ds_read_b128 v[184:187], v2 offset:8704
    s_waitcnt lgkmcnt(5)
    v_mfma_f32_16x16x32_bf16 v[136:139], v[200:203], v[36:39], v[136:139]
    v_exp_f32 v14, v158
    v_mfma_f32_16x16x32_bf16 v[140:143], v[200:203], v[52:55], v[140:143]
    ds_read_b128 v[188:191], v2 offset:8768
    v_cvt_pk_bf16_f32 v179, v16, v17
    v_mfma_f32_16x16x32_bf16 v[96:99], v[204:207], v[168:171], v[96:99]
    v_exp_f32 v15, v159
    v_mfma_f32_16x16x32_bf16 v[100:103], v[204:207], v[172:175], v[100:103]
    ds_read_b128 v[192:195], v2 offset:8832
    s_waitcnt lgkmcnt(3)
    v_mfma_f32_16x16x32_bf16 v[104:107], v[208:211], v[168:171], v[104:107]
    v_cvt_pk_bf16_f32 v182, v12, v13
    v_or3_b32 v0, v0, v179, v182
    v_cvt_pk_bf16_f32 v183, v14, v15
    v_mfma_f32_16x16x32_bf16 v[108:111], v[208:211], v[172:175], v[108:111]
    ds_read_b64_tr_b16 v[196:197], v3 offset:8704
    ds_read_b64_tr_b16 v[198:199], v3 offset:13056
    v_mfma_f32_16x16x32_bf16 v[112:115], v[212:215], v[168:171], v[112:115]
    v_bitop3_b32 v0, v0, v183, s61 bitop3:0xa8
    v_cmp_ne_u32 vcc, 0, v0
    v_mfma_f32_16x16x32_bf16 v[116:119], v[212:215], v[172:175], v[116:119]
    ds_read_b128 v[200:203], v2 offset:8896
    s_cbranch_vccnz L_fbs2
L_fbr2:
    s_waitcnt lgkmcnt(4)
    v_mfma_f32_16x16x32_bf16 v[144:147], v[184:187], v[24:27], v[160:163]
    v_exp_f32 v12, v128
    v_mfma_f32_16x16x32_bf16 v[148:151], v[184:187], v[40:43], v[164:167]
    ds_read_b64_tr_b16 v[204:205], v4 offset:8704
    ds_read_b64_tr_b16 v[206:207], v4 offset:13056
    v_mfma_f32_16x16x32_bf16 v[144:147], v[188:191], v[28:31], v[144:147]
    v_exp_f32 v13, v129
    v_mfma_f32_16x16x32_bf16 v[148:151], v[188:191], v[44:47], v[148:151]
    ds_read_b128 v[208:211], v2 offset:13056
    v_cvt_pk_bf16_f32 v168, v12, v13
    s_waitcnt lgkmcnt(4)
    v_mfma_f32_16x16x32_bf16 v[144:147], v[192:195], v[32:35], v[144:147]
    v_exp_f32 v14, v130
    v_mfma_f32_16x16x32_bf16 v[148:151], v[192:195], v[48:51], v[148:151]
    ds_read_b64_tr_b16 v[212:213], v3 offset:8768
    ds_read_b64_tr_b16 v[214:215], v3 offset:13120
    v_mfma_f32_16x16x32_bf16 v[120:123], v[8:11], v[176:179], v[120:123]
    v_exp_f32 v15, v131
    v_mfma_f32_16x16x32_bf16 v[124:127], v[8:11], v[180:183], v[124:127]
    v_exp_f32 v16, v132
    v_cvt_pk_bf16_f32 v169, v14, v15
    v_mfma_f32_16x16x32_bf16 v[56:59], v[196:199], v[176:179], v[56:59]
    v_exp_f32 v17, v133
    v_mfma_f32_16x16x32_bf16 v[60:63], v[196:199], v[180:183], v[60:63]
    ds_read_b128 v[184:187], v2 offset:13120
    v_cvt_pk_bf16_f32 v172, v16, v17
    s_waitcnt lgkmcnt(4)
    v_mfma_f32_16x16x32_bf16 v[144:147], v[200:203], v[36:39], v[144:147]
    v_exp_f32 v12, v134
    v_or3_b32 v0, v168, v169, v172
    v_mfma_f32_16x16x32_bf16 v[148:151], v[200:203], v[52:55], v[148:151]
    ds_read_b64_tr_b16 v[188:189], v4 offset:8768
    ds_read_b64_tr_b16 v[190:191], v4 offset:13120
    v_mfma_f32_16x16x32_bf16 v[64:67], v[204:207], v[176:179], v[64:67]
    v_exp_f32 v13, v135
    v_mfma_f32_16x16x32_bf16 v[68:71], v[204:207], v[180:183], v[68:71]
    ds_read_b128 v[192:195], v2 offset:13184
    v_cvt_pk_bf16_f32 v173, v12, v13
    s_waitcnt lgkmcnt(4)
    v_mfma_f32_16x16x32_bf16 v[152:155], v[208:211], v[24:27], v[160:163]
    v_exp_f32 v14, v136
    v_mfma_f32_16x16x32_bf16 v[156:159], v[208:211], v[40:43], v[164:167]
    ds_read_b64_tr_b16 v[196:197], v3 offset:8832
    ds_read_b64_tr_b16 v[198:199], v3 offset:13184
    v_mfma_f32_16x16x32_bf16 v[72:75], v[212:215], v[176:179], v[72:75]
    v_exp_f32 v15, v137
    v_mfma_f32_16x16x32_bf16 v[76:79], v[212:215], v[180:183], v[76:79]
    ds_read_b128 v[200:203], v2 offset:13248
    v_cvt_pk_bf16_f32 v170, v14, v15
    v_add_u32 v2, s63, v5
    s_waitcnt lgkmcnt(4)
    v_mfma_f32_16x16x32_bf16 v[152:155], v[184:187], v[28:31], v[152:155]
    v_exp_f32 v16, v138
    v_or3_b32 v0, v0, v173, v170
    v_mfma_f32_16x16x32_bf16 v[156:159], v[184:187], v[44:47], v[156:159]
    ds_read_b64_tr_b16 v[204:205], v4 offset:8832
    ds_read_b64_tr_b16 v[206:207], v4 offset:13184
    v_mfma_f32_16x16x32_bf16 v[80:83], v[188:191], v[176:179], v[80:83]
    v_exp_f32 v17, v139
    v_mfma_f32_16x16x32_bf16 v[84:87], v[188:191], v[180:183], v[84:87]
    ds_read_b64_tr_b16 v[208:209], v3 offset:8896
    ds_read_b64_tr_b16 v[210:211], v3 offset:13248
    v_add_u32 v3, s63, v6
    s_waitcnt lgkmcnt(5)
    v_mfma_f32_16x16x32_bf16 v[152:155], v[192:195], v[32:35], v[152:155]
    v_exp_f32 v12, v140
    v_mfma_f32_16x16x32_bf16 v[156:159], v[192:195], v[48:51], v[156:159]
    ds_read_b64_tr_b16 v[212:213], v4 offset:8896
    ds_read_b64_tr_b16 v[214:215], v4 offset:13248
    v_add_u32 v4, s63, v7
    s_sub_u32 s62, s62, 1
    v_mfma_f32_16x16x32_bf16 v[88:91], v[196:199], v[176:179], v[88:91]
    v_exp_f32 v13, v141
    v_mfma_f32_16x16x32_bf16 v[92:95], v[196:199], v[180:183], v[92:95]
    s_barrier
    s_cbranch_scc0 L_loop
    s_sub_u32 s62, s68, 1
    s_cbranch_scc0 L_hooks
L_epi:
    s_cmp_eq_u32 s23, 1
    s_cselect_b32 s69, 1, s69
    s_cmp_eq_u32 s69, 0
    s_cbranch_scc0 L_nolk
    s_call_b64 s[64:65], L_hook
L_nolk:
    ds_read_b64_tr_b16 v[184:185], v3 offset:0
    ds_read_b64_tr_b16 v[186:187], v3 offset:4352
    s_waitcnt lgkmcnt(8)
    v_mfma_f32_16x16x32_bf16 v[152:155], v[200:203], v[36:39], v[152:155]
    v_exp_f32 v14, v142
    v_mfma_f32_16x16x32_bf16 v[156:159], v[200:203], v[52:55], v[156:159]
    ds_read_b64_tr_b16 v[188:189], v4 offset:0
    ds_read_b64_tr_b16 v[190:191], v4 offset:4352
    v_cvt_pk_bf16_f32 v171, v16, v17
    s_waitcnt lgkmcnt(8)
    v_mfma_f32_16x16x32_bf16 v[96:99], v[204:207], v[176:179], v[96:99]
    v_exp_f32 v15, v143
    v_mfma_f32_16x16x32_bf16 v[100:103], v[204:207], v[180:183], v[100:103]
    ds_read_b64_tr_b16 v[192:193], v3 offset:64
    ds_read_b64_tr_b16 v[194:195], v3 offset:4416
    s_waitcnt lgkmcnt(8)
    v_mfma_f32_16x16x32_bf16 v[104:107], v[208:211], v[176:179], v[104:107]
    v_cvt_pk_bf16_f32 v174, v12, v13
    v_or3_b32 v0, v0, v171, v174
    v_cvt_pk_bf16_f32 v175, v14, v15
    v_mfma_f32_16x16x32_bf16 v[108:111], v[208:211], v[180:183], v[108:111]
    ds_read_b64_tr_b16 v[196:197], v4 offset:64
    ds_read_b64_tr_b16 v[198:199], v4 offset:4416
    s_waitcnt lgkmcnt(8)
    v_mfma_f32_16x16x32_bf16 v[112:115], v[212:215], v[176:179], v[112:115]
    v_bitop3_b32 v0, v0, v175, s61 bitop3:0xa8
    v_cmp_ne_u32 vcc, 0, v0
    v_mfma_f32_16x16x32_bf16 v[116:119], v[212:215], v[180:183], v[116:119]
    ds_read_b64_tr_b16 v[200:201], v3 offset:128
    ds_read_b64_tr_b16 v[202:203], v3 offset:4480
    s_cbranch_vccnz L_fbs3
L_fbr3:
    s_waitcnt lgkmcnt(8)
    v_mfma_f32_16x16x32_bf16 v[120:123], v[8:11], v[168:171], v[120:123]
    v_exp_f32 v12, v144
    v_mfma_f32_16x16x32_bf16 v[124:127], v[8:11], v[172:175], v[124:127]
    v_exp_f32 v13, v145
    v_exp_f32 v14, v146
    v_mfma_f32_16x16x32_bf16 v[56:59], v[184:187], v[168:171], v[56:59]
    v_exp_f32 v15, v147
    v_mfma_f32_16x16x32_bf16 v[60:63], v[184:187], v[172:175], v[60:63]
    ds_read_b64_tr_b16 v[204:205], v4 offset:128
    ds_read_b64_tr_b16 v[206:207], v4 offset:4480
    v_cvt_pk_bf16_f32 v176, v12, v13
    v_exp_f32 v16, v148
    s_waitcnt lgkmcnt(8)
    v_mfma_f32_16x16x32_bf16 v[64:67], v[188:191], v[168:171], v[64:67]
    v_exp_f32 v17, v149
    v_mfma_f32_16x16x32_bf16 v[68:71], v[188:191], v[172:175], v[68:71]
    ds_read_b64_tr_b16 v[208:209], v3 offset:192
    ds_read_b64_tr_b16 v[210:211], v3 offset:4544
    v_cvt_pk_bf16_f32 v177, v14, v15
    v_exp_f32 v12, v150
    s_waitcnt lgkmcnt(8)
    v_mfma_f32_16x16x32_bf16 v[72:75], v[192:195], v[168:171], v[72:75]
    v_exp_f32 v13, v151
    v_cvt_pk_bf16_f32 v180, v16, v17
    v_mfma_f32_16x16x32_bf16 v[76:79], v[192:195], v[172:175], v[76:79]
    ds_read_b64_tr_b16 v[212:213], v4 offset:192
    ds_read_b64_tr_b16 v[214:215], v4 offset:4544
    v_or3_b32 v0, v176, v177, v180
    v_exp_f32 v14, v152
    s_waitcnt lgkmcnt(8)
    v_mfma_f32_16x16x32_bf16 v[80:83], v[196:199], v[168:171], v[80:83]
    v_exp_f32 v15, v153
    v_mfma_f32_16x16x32_bf16 v[84:87], v[196:199], v[172:175], v[84:87]
    s_barrier
    ds_read_b64_tr_b16 v[184:185], v3 offset:8704
    ds_read_b64_tr_b16 v[186:187], v3 offset:13056
    v_cvt_pk_bf16_f32 v181, v12, v13
    v_exp_f32 v16, v154
    s_waitcnt lgkmcnt(8)
    v_mfma_f32_16x16x32_bf16 v[88:91], v[200:203], v[168:171], v[88:91]
    v_exp_f32 v17, v155
    v_mfma_f32_16x16x32_bf16 v[92:95], v[200:203], v[172:175], v[92:95]
    ds_read_b64_tr_b16 v[188:189], v4 offset:8704
    ds_read_b64_tr_b16 v[190:191], v4 offset:13056
    v_cvt_pk_bf16_f32 v178, v14, v15
    v_or3_b32 v0, v0, v181, v178
    s_waitcnt lgkmcnt(8)
    v_mfma_f32_16x16x32_bf16 v[96:99], v[204:207], v[168:171], v[96:99]
    v_exp_f32 v12, v156
    v_exp_f32 v13, v157
    v_mfma_f32_16x16x32_bf16 v[100:103], v[204:207], v[172:175], v[100:103]
    ds_read_b64_tr_b16 v[192:193], v3 offset:8768
    ds_read_b64_tr_b16 v[194:195], v3 offset:13120
    v_cvt_pk_bf16_f32 v179, v16, v17
    v_exp_f32 v14, v158
    s_waitcnt lgkmcnt(8)
    v_mfma_f32_16x16x32_bf16 v[104:107], v[208:211], v[168:171], v[104:107]
    v_exp_f32 v15, v159
    v_mfma_f32_16x16x32_bf16 v[108:111], v[208:211], v[172:175], v[108:111]
    ds_read_b64_tr_b16 v[196:197], v4 offset:8768
    ds_read_b64_tr_b16 v[198:199], v4 offset:13120
    v_cvt_pk_bf16_f32 v182, v12, v13
    v_or3_b32 v0, v0, v179, v182
    s_waitcnt lgkmcnt(8)
    v_mfma_f32_16x16x32_bf16 v[112:115], v[212:215], v[168:171], v[112:115]
    v_cvt_pk_bf16_f32 v183, v14, v15
    v_bitop3_b32 v0, v0, v183, s61 bitop3:0xa8
    v_cmp_ne_u32 vcc, 0, v0
    v_mfma_f32_16x16x32_bf16 v[116:119], v[212:215], v[172:175], v[116:119]
    ds_read_b64_tr_b16 v[200:201], v3 offset:8832
    ds_read_b64_tr_b16 v[202:203], v3 offset:13184
    s_cbranch_vccnz L_fbs4
L_fbr4:
    s_add_u32 s63, s63, 34816
    s_cmp_eq_u32 s63, 104448
    s_cselect_b32 s63, 0, s63
    v_sub_f32 v144, 0, v160
    v_sub_f32 v145, 0, v164
    s_cmp_eq_u32 s23, 1
    s_cbranch_scc0 L_helper
    s_cmp_eq_u32 s51, 2
    s_cbranch_scc0 L_own13
    s_add_u32 s58, s59, 4096
    s_lshl_b32 s24, s20, 8
    v_and_b32 v15, 0xf0, v23
    v_add_u32 v15, s24, v15
    v_add_u32 v12, 104448, v15
    s_add_u32 s24, s25, 104448
    v_add_u32 v13, s24, v23
    s_barrier
    ds_read_b128 v[148:151], v12 offset:32768
    s_waitcnt lgkmcnt(9)
    v_mfma_f32_16x16x32_bf16 v[120:123], v[8:11], v[176:179], v[120:123]
    s_add_u32 s24, s25, 104448
    v_mfma_f32_16x16x32_bf16 v[124:127], v[8:11], v[180:183], v[124:127]
    v_bfe_u32 v163, v1, 1, 2
    v_mfma_f32_16x16x32_bf16 v[56:59], v[184:187], v[176:179], v[56:59]
    v_lshrrev_b32 v164, 5, v1
    v_mfma_f32_16x16x32_bf16 v[60:63], v[184:187], v[180:183], v[60:63]
    ds_read_b64_tr_b16 v[204:205], v4 offset:8832
    ds_read_b64_tr_b16 v[206:207], v4 offset:13184
    v_xor_b32 v163, v163, v164
    s_waitcnt lgkmcnt(9)
    v_mfma_f32_16x16x32_bf16 v[64:67], v[188:191], v[176:179], v[64:67]
    v_and_b32 v164, 15, v1
    v_lshl_add_u32 v164, v164, 6, s24
    v_lshl_add_u32 v163, v163, 4, v164
    v_mfma_f32_16x16x32_bf16 v[68:71], v[188:191], v[180:183], v[68:71]
    ds_read_b64_tr_b16 v[208:209], v3 offset:8896
    ds_read_b64_tr_b16 v[210:211], v3 offset:13248
    v_bfe_u32 v164, v1, 4, 1
    v_lshl_add_u32 v160, v164, 3, v163
    s_waitcnt lgkmcnt(9)
    v_mfma_f32_16x16x32_bf16 v[72:75], v[192:195], v[176:179], v[72:75]
    v_xor_b32 v161, 32, v160
    v_bfe_u32 v163, v1, 3, 2
    v_mfma_f32_16x16x32_bf16 v[76:79], v[192:195], v[180:183], v[76:79]
    ds_read_b64_tr_b16 v[212:213], v4 offset:8896
    ds_read_b64_tr_b16 v[214:215], v4 offset:13248
    v_lshlrev_b32 v163, 4, v163
    v_xor_b32 v163, v163, v23
    v_add_u32 v162, s24, v163
    s_waitcnt lgkmcnt(9)
    v_mfma_f32_16x16x32_bf16 v[80:83], v[196:199], v[176:179], v[80:83]
    s_waitcnt lgkmcnt(6)
    v_max_f32 v156, v144, v148
    v_mfma_f32_16x16x32_bf16 v[84:87], v[196:199], v[180:183], v[84:87]
    v_max_f32 v157, v145, v149
    v_sub_f32 v144, v144, v156
    ds_read_b128 v[224:227], v13 offset:0
    v_mfma_f32_16x16x32_bf16 v[88:91], v[200:203], v[176:179], v[88:91]
    v_sub_f32 v145, v145, v157
    v_sub_f32 v148, v148, v156
    ds_read_b128 v[228:231], v13 offset:1024
    v_mfma_f32_16x16x32_bf16 v[92:95], v[200:203], v[180:183], v[92:95]
    v_sub_f32 v149, v149, v157
    v_exp_f32 v144, v144
    ds_read_b128 v[232:235], v13 offset:2048
    s_waitcnt lgkmcnt(7)
    v_mfma_f32_16x16x32_bf16 v[96:99], v[204:207], v[176:179], v[96:99]
    v_exp_f32 v145, v145
    v_exp_f32 v148, v148
    v_exp_f32 v149, v149
    ds_read_b128 v[236:239], v13 offset:3072
    v_mfma_f32_16x16x32_bf16 v[100:103], v[204:207], v[180:183], v[100:103]
    v_mul_f32 v146, v144, v120
    v_mul_f32 v147, v145, v124
    ds_read_b128 v[240:243], v13 offset:4096
    s_waitcnt lgkmcnt(7)
    v_mfma_f32_16x16x32_bf16 v[104:107], v[208:211], v[176:179], v[104:107]
    v_fmac_f32 v146, v148, v150
    v_fmac_f32 v147, v149, v151
    ds_read_b128 v[244:247], v13 offset:5120
    v_mfma_f32_16x16x32_bf16 v[108:111], v[208:211], v[180:183], v[108:111]
    v_rcp_f32 v146, v146
    v_rcp_f32 v147, v147
    ds_read_b128 v[248:251], v13 offset:6144
    s_waitcnt lgkmcnt(7)
    v_mfma_f32_16x16x32_bf16 v[112:115], v[212:215], v[176:179], v[112:115]
    s_nop 0
    v_mul_f32 v144, v144, v146
    ds_read_b128 v[252:255], v13 offset:7168
    v_mfma_f32_16x16x32_bf16 v[116:119], v[212:215], v[180:183], v[116:119]
    v_mul_f32 v145, v145, v147
    v_mul_f32 v148, v148, v146
    v_mul_f32 v149, v149, v147
    s_waitcnt lgkmcnt(7)
    v_lshlrev_b32 v128, 16, v224
    v_and_b32 v129, 0xffff0000, v224
    v_lshlrev_b32 v130, 16, v225
    v_and_b32 v131, 0xffff0000, v225
    v_lshlrev_b32 v132, 16, v226
    v_and_b32 v133, 0xffff0000, v226
    v_lshlrev_b32 v134, 16, v227
    v_and_b32 v135, 0xffff0000, v227
    v_pk_mul_f32 v[56:57], v[56:57], v[144:145] op_sel:[0,0] op_sel_hi:[1,0]
    v_pk_mul_f32 v[58:59], v[58:59], v[144:145] op_sel:[0,0] op_sel_hi:[1,0]
    v_pk_mul_f32 v[60:61], v[60:61], v[144:145] op_sel:[0,1] op_sel_hi:[1,1]
    v_pk_mul_f32 v[62:63], v[62:63], v[144:145] op_sel:[0,1] op_sel_hi:[1,1]
    v_pk_fma_f32 v[56:57], v[128:129], v[148:149], v[56:57] op_sel:[0,0,0] op_sel_hi:[1,0,1]
    v_pk_fma_f32 v[58:59], v[130:131], v[148:149], v[58:59] op_sel:[0,0,0] op_sel_hi:[1,0,1]
    v_pk_fma_f32 v[60:61], v[132:133], v[148:149], v[60:61] op_sel:[0,1,0] op_sel_hi:[1,1,1]
    v_pk_fma_f32 v[62:63], v[134:135], v[148:149], v[62:63] op_sel:[0,1,0] op_sel_hi:[1,1,1]
    s_waitcnt lgkmcnt(6)
    v_lshlrev_b32 v128, 16, v228
    v_and_b32 v129, 0xffff0000, v228
    v_lshlrev_b32 v130, 16, v229
    v_and_b32 v131, 0xffff0000, v229
    v_lshlrev_b32 v132, 16, v230
    v_and_b32 v133, 0xffff0000, v230
    v_lshlrev_b32 v134, 16, v231
    v_and_b32 v135, 0xffff0000, v231
    v_pk_mul_f32 v[64:65], v[64:65], v[144:145] op_sel:[0,0] op_sel_hi:[1,0]
    v_pk_mul_f32 v[66:67], v[66:67], v[144:145] op_sel:[0,0] op_sel_hi:[1,0]
    v_pk_mul_f32 v[68:69], v[68:69], v[144:145] op_sel:[0,1] op_sel_hi:[1,1]
    v_pk_mul_f32 v[70:71], v[70:71], v[144:145] op_sel:[0,1] op_sel_hi:[1,1]
    v_pk_fma_f32 v[64:65], v[128:129], v[148:149], v[64:65] op_sel:[0,0,0] op_sel_hi:[1,0,1]
    v_pk_fma_f32 v[66:67], v[130:131], v[148:149], v[66:67] op_sel:[0,0,0] op_sel_hi:[1,0,1]
    v_pk_fma_f32 v[68:69], v[132:133], v[148:149], v[68:69] op_sel:[0,1,0] op_sel_hi:[1,1,1]
    v_pk_fma_f32 v[70:71], v[134:135], v[148:149], v[70:71] op_sel:[0,1,0] op_sel_hi:[1,1,1]
    v_cvt_pk_bf16_f32 v184, v56, v57
    v_cvt_pk_bf16_f32 v185, v58, v59
    v_cvt_pk_bf16_f32 v186, v64, v65
    v_cvt_pk_bf16_f32 v187, v66, v67
    v_cvt_pk_bf16_f32 v188, v60, v61
    v_cvt_pk_bf16_f32 v189, v62, v63
    v_cvt_pk_bf16_f32 v190, v68, v69
    v_cvt_pk_bf16_f32 v191, v70, v71
    ds_write_b64 v160, v[184:185] offset:0
    ds_write_b64 v161, v[186:187] offset:0
    ds_read_b128 v[184:187], v162 offset:0
    ds_write_b64 v160, v[188:189] offset:1024
    ds_write_b64 v161, v[190:191] offset:1024
    ds_read_b128 v[188:191], v162 offset:1024
    s_waitcnt lgkmcnt(11)
    v_lshlrev_b32 v128, 16, v232
    v_and_b32 v129, 0xffff0000, v232
    v_lshlrev_b32 v130, 16, v233
    v_and_b32 v131, 0xffff0000, v233
    v_lshlrev_b32 v132, 16, v234
    v_and_b32 v133, 0xffff0000, v234
    v_lshlrev_b32 v134, 16, v235
    v_and_b32 v135, 0xffff0000, v235
    v_pk_mul_f32 v[72:73], v[72:73], v[144:145] op_sel:[0,0] op_sel_hi:[1,0]
    v_pk_mul_f32 v[74:75], v[74:75], v[144:145] op_sel:[0,0] op_sel_hi:[1,0]
    v_pk_mul_f32 v[76:77], v[76:77], v[144:145] op_sel:[0,1] op_sel_hi:[1,1]
    v_pk_mul_f32 v[78:79], v[78:79], v[144:145] op_sel:[0,1] op_sel_hi:[1,1]
    v_pk_fma_f32 v[72:73], v[128:129], v[148:149], v[72:73] op_sel:[0,0,0] op_sel_hi:[1,0,1]
    v_pk_fma_f32 v[74:75], v[130:131], v[148:149], v[74:75] op_sel:[0,0,0] op_sel_hi:[1,0,1]
    v_pk_fma_f32 v[76:77], v[132:133], v[148:149], v[76:77] op_sel:[0,1,0] op_sel_hi:[1,1,1]
    v_pk_fma_f32 v[78:79], v[134:135], v[148:149], v[78:79] op_sel:[0,1,0] op_sel_hi:[1,1,1]
    s_waitcnt lgkmcnt(3)
    buffer_store_dwordx4 v[184:187], v19, s[40:43], s59 offen offset:0 nt
    v_lshlrev_b32 v128, 16, v236
    v_and_b32 v129, 0xffff0000, v236
    v_lshlrev_b32 v130, 16, v237
    v_and_b32 v131, 0xffff0000, v237
    v_lshlrev_b32 v132, 16, v238
    v_and_b32 v133, 0xffff0000, v238
    v_lshlrev_b32 v134, 16, v239
    v_and_b32 v135, 0xffff0000, v239
    v_pk_mul_f32 v[80:81], v[80:81], v[144:145] op_sel:[0,0] op_sel_hi:[1,0]
    v_pk_mul_f32 v[82:83], v[82:83], v[144:145] op_sel:[0,0] op_sel_hi:[1,0]
    v_pk_mul_f32 v[84:85], v[84:85], v[144:145] op_sel:[0,1] op_sel_hi:[1,1]
    v_pk_mul_f32 v[86:87], v[86:87], v[144:145] op_sel:[0,1] op_sel_hi:[1,1]
    v_pk_fma_f32 v[80:81], v[128:129], v[148:149], v[80:81] op_sel:[0,0,0] op_sel_hi:[1,0,1]
    v_pk_fma_f32 v[82:83], v[130:131], v[148:149], v[82:83] op_sel:[0,0,0] op_sel_hi:[1,0,1]
    v_pk_fma_f32 v[84:85], v[132:133], v[148:149], v[84:85] op_sel:[0,1,0] op_sel_hi:[1,1,1]
    v_pk_fma_f32 v[86:87], v[134:135], v[148:149], v[86:87] op_sel:[0,1,0] op_sel_hi:[1,1,1]
    s_waitcnt lgkmcnt(0)
    buffer_store_dwordx4 v[188:191], v19, s[40:43], s58 offen offset:0 nt
    v_cvt_pk_bf16_f32 v192, v72, v73
    v_cvt_pk_bf16_f32 v193, v74, v75
    v_cvt_pk_bf16_f32 v194, v80, v81
    v_cvt_pk_bf16_f32 v195, v82, v83
    v_cvt_pk_bf16_f32 v196, v76, v77
    v_cvt_pk_bf16_f32 v197, v78, v79
    v_cvt_pk_bf16_f32 v198, v84, v85
    v_cvt_pk_bf16_f32 v199, v86, v87
    ds_write_b64 v160, v[192:193] offset:2048
    ds_write_b64 v161, v[194:195] offset:2048
    ds_read_b128 v[192:195], v162 offset:2048
    ds_write_b64 v160, v[196:197] offset:3072
    ds_write_b64 v161, v[198:199] offset:3072
    ds_read_b128 v[196:199], v162 offset:3072
    v_lshlrev_b32 v128, 16, v240
    v_and_b32 v129, 0xffff0000, v240
    v_lshlrev_b32 v130, 16, v241
    v_and_b32 v131, 0xffff0000, v241
    v_lshlrev_b32 v132, 16, v242
    v_and_b32 v133, 0xffff0000, v242
    v_lshlrev_b32 v134, 16, v243
    v_and_b32 v135, 0xffff0000, v243
    v_pk_mul_f32 v[88:89], v[88:89], v[144:145] op_sel:[0,0] op_sel_hi:[1,0]
    v_pk_mul_f32 v[90:91], v[90:91], v[144:145] op_sel:[0,0] op_sel_hi:[1,0]
    v_pk_mul_f32 v[92:93], v[92:93], v[144:145] op_sel:[0,1] op_sel_hi:[1,1]
    v_pk_mul_f32 v[94:95], v[94:95], v[144:145] op_sel:[0,1] op_sel_hi:[1,1]
    v_pk_fma_f32 v[88:89], v[128:129], v[148:149], v[88:89] op_sel:[0,0,0] op_sel_hi:[1,0,1]
    v_pk_fma_f32 v[90:91], v[130:131], v[148:149], v[90:91] op_sel:[0,0,0] op_sel_hi:[1,0,1]
    v_pk_fma_f32 v[92:93], v[132:133], v[148:149], v[92:93] op_sel:[0,1,0] op_sel_hi:[1,1,1]
    v_pk_fma_f32 v[94:95], v[134:135], v[148:149], v[94:95] op_sel:[0,1,0] op_sel_hi:[1,1,1]
    s_waitcnt lgkmcnt(3)
    buffer_store_dwordx4 v[192:195], v19, s[40:43], s59 offen offset:64 nt
    v_lshlrev_b32 v128, 16, v244
    v_and_b32 v129, 0xffff0000, v244
    v_lshlrev_b32 v130, 16, v245
    v_and_b32 v131, 0xffff0000, v245
    v_lshlrev_b32 v132, 16, v246
    v_and_b32 v133, 0xffff0000, v246
    v_lshlrev_b32 v134, 16, v247
    v_and_b32 v135, 0xffff0000, v247
    v_pk_mul_f32 v[96:97], v[96:97], v[144:145] op_sel:[0,0] op_sel_hi:[1,0]
    v_pk_mul_f32 v[98:99], v[98:99], v[144:145] op_sel:[0,0] op_sel_hi:[1,0]
    v_pk_mul_f32 v[100:101], v[100:101], v[144:145] op_sel:[0,1] op_sel_hi:[1,1]
    v_pk_mul_f32 v[102:103], v[102:103], v[144:145] op_sel:[0,1] op_sel_hi:[1,1]
    v_pk_fma_f32 v[96:97], v[128:129], v[148:149], v[96:97] op_sel:[0,0,0] op_sel_hi:[1,0,1]
    v_pk_fma_f32 v[98:99], v[130:131], v[148:149], v[98:99] op_sel:[0,0,0] op_sel_hi:[1,0,1]
    v_pk_fma_f32 v[100:101], v[132:133], v[148:149], v[100:101] op_sel:[0,1,0] op_sel_hi:[1,1,1]
    v_pk_fma_f32 v[102:103], v[134:135], v[148:149], v[102:103] op_sel:[0,1,0] op_sel_hi:[1,1,1]
    s_waitcnt lgkmcnt(0)
    buffer_store_dwordx4 v[196:199], v19, s[40:43], s58 offen offset:64 nt
    v_cvt_pk_bf16_f32 v200, v88, v89
    v_cvt_pk_bf16_f32 v201, v90, v91
    v_cvt_pk_bf16_f32 v202, v96, v97
    v_cvt_pk_bf16_f32 v203, v98, v99
    v_cvt_pk_bf16_f32 v204, v92, v93
    v_cvt_pk_bf16_f32 v205, v94, v95
    v_cvt_pk_bf16_f32 v206, v100, v101
    v_cvt_pk_bf16_f32 v207, v102, v103
    ds_write_b64 v160, v[200:201] offset:4096
    ds_write_b64 v161, v[202:203] offset:4096
    ds_read_b128 v[200:203], v162 offset:4096
    ds_write_b64 v160, v[204:205] offset:5120
    ds_write_b64 v161, v[206:207] offset:5120
    ds_read_b128 v[204:207], v162 offset:5120
    v_lshlrev_b32 v128, 16, v248
    v_and_b32 v129, 0xffff0000, v248
    v_lshlrev_b32 v130, 16, v249
    v_and_b32 v131, 0xffff0000, v249
    v_lshlrev_b32 v132, 16, v250
    v_and_b32 v133, 0xffff0000, v250
    v_lshlrev_b32 v134, 16, v251
    v_and_b32 v135, 0xffff0000, v251
    v_pk_mul_f32 v[104:105], v[104:105], v[144:145] op_sel:[0,0] op_sel_hi:[1,0]
    v_pk_mul_f32 v[106:107], v[106:107], v[144:145] op_sel:[0,0] op_sel_hi:[1,0]
    v_pk_mul_f32 v[108:109], v[108:109], v[144:145] op_sel:[0,1] op_sel_hi:[1,1]
    v_pk_mul_f32 v[110:111], v[110:111], v[144:145] op_sel:[0,1] op_sel_hi:[1,1]
    v_pk_fma_f32 v[104:105], v[128:129], v[148:149], v[104:105] op_sel:[0,0,0] op_sel_hi:[1,0,1]
    v_pk_fma_f32 v[106:107], v[130:131], v[148:149], v[106:107] op_sel:[0,0,0] op_sel_hi:[1,0,1]
    v_pk_fma_f32 v[108:109], v[132:133], v[148:149], v[108:109] op_sel:[0,1,0] op_sel_hi:[1,1,1]
    v_pk_fma_f32 v[110:111], v[134:135], v[148:149], v[110:111] op_sel:[0,1,0] op_sel_hi:[1,1,1]
    s_waitcnt lgkmcnt(3)
    buffer_store_dwordx4 v[200:203], v19, s[40:43], s59 offen offset:128 nt
    v_lshlrev_b32 v128, 16, v252
    v_and_b32 v129, 0xffff0000, v252
    v_lshlrev_b32 v130, 16, v253
    v_and_b32 v131, 0xffff0000, v253
    v_lshlrev_b32 v132, 16, v254
    v_and_b32 v133, 0xffff0000, v254
    v_lshlrev_b32 v134, 16, v255
    v_and_b32 v135, 0xffff0000, v255
    v_pk_mul_f32 v[112:113], v[112:113], v[144:145] op_sel:[0,0] op_sel_hi:[1,0]
    v_pk_mul_f32 v[114:115], v[114:115], v[144:145] op_sel:[0,0] op_sel_hi:[1,0]
    v_pk_mul_f32 v[116:117], v[116:117], v[144:145] op_sel:[0,1] op_sel_hi:[1,1]
    v_pk_mul_f32 v[118:119], v[118:119], v[144:145] op_sel:[0,1] op_sel_hi:[1,1]
    v_pk_fma_f32 v[112:113], v[128:129], v[148:149], v[112:113] op_sel:[0,0,0] op_sel_hi:[1,0,1]
    v_pk_fma_f32 v[114:115], v[130:131], v[148:149], v[114:115] op_sel:[0,0,0] op_sel_hi:[1,0,1]
    v_pk_fma_f32 v[116:117], v[132:133], v[148:149], v[116:117] op_sel:[0,1,0] op_sel_hi:[1,1,1]
    v_pk_fma_f32 v[118:119], v[134:135], v[148:149], v[118:119] op_sel:[0,1,0] op_sel_hi:[1,1,1]
    s_waitcnt lgkmcnt(0)
    buffer_store_dwordx4 v[204:207], v19, s[40:43], s58 offen offset:128 nt
    v_cvt_pk_bf16_f32 v208, v104, v105
    v_cvt_pk_bf16_f32 v209, v106, v107
    v_cvt_pk_bf16_f32 v210, v112, v113
    v_cvt_pk_bf16_f32 v211, v114, v115
    v_cvt_pk_bf16_f32 v212, v108, v109
    v_cvt_pk_bf16_f32 v213, v110, v111
    v_cvt_pk_bf16_f32 v214, v116, v117
    v_cvt_pk_bf16_f32 v215, v118, v119
    ds_write_b64 v160, v[208:209] offset:6144
    ds_write_b64 v161, v[210:211] offset:6144
    ds_read_b128 v[208:211], v162 offset:6144
    ds_write_b64 v160, v[212:213] offset:7168
    ds_write_b64 v161, v[214:215] offset:7168
    ds_read_b128 v[212:215], v162 offset:7168
    s_waitcnt lgkmcnt(3)
    buffer_store_dwordx4 v[208:211], v19, s[40:43], s59 offen offset:192 nt
    s_waitcnt lgkmcnt(0)
    buffer_store_dwordx4 v[212:215], v19, s[40:43], s58 offen offset:192 nt
    s_branch L_done
L_own13:
    s_cmp_eq_u32 s51, 3
    s_cbranch_scc0 L_solo
    s_add_u32 s58, s59, 4096
    s_lshl_b32 s24, s20, 8
    v_and_b32 v15, 0xf0, v23
    v_add_u32 v15, s24, v15
    v_add_u32 v12, 104448, v15
    s_add_u32 s24, s25, 104448
    v_add_u32 v13, s24, v23
    v_add_u32 v15, s63, v15
    s_add_u32 s24, s25, s63
    v_add_u32 v14, s24, v23
    s_barrier
    ds_read_b128 v[148:151], v12 offset:32768
    ds_read_b128 v[152:155], v15 offset:32768
    s_waitcnt lgkmcnt(10)
    v_mfma_f32_16x16x32_bf16 v[120:123], v[8:11], v[176:179], v[120:123]
    s_add_u32 s24, s25, 104448
    v_mfma_f32_16x16x32_bf16 v[124:127], v[8:11], v[180:183], v[124:127]
    v_bfe_u32 v163, v1, 1, 2
    v_mfma_f32_16x16x32_bf16 v[56:59], v[184:187], v[176:179], v[56:59]
    v_lshrrev_b32 v164, 5, v1
    v_mfma_f32_16x16x32_bf16 v[60:63], v[184:187], v[180:183], v[60:63]
    ds_read_b64_tr_b16 v[204:205], v4 offset:8832
    ds_read_b64_tr_b16 v[206:207], v4 offset:13184
    v_xor_b32 v163, v163, v164
    s_waitcnt lgkmcnt(10)
    v_mfma_f32_16x16x32_bf16 v[64:67], v[188:191], v[176:179], v[64:67]
    v_and_b32 v164, 15, v1
    v_lshl_add_u32 v164, v164, 6, s24
    v_lshl_add_u32 v163, v163, 4, v164
    v_mfma_f32_16x16x32_bf16 v[68:71], v[188:191], v[180:183], v[68:71]
    ds_read_b64_tr_b16 v[208:209], v3 offset:8896
    ds_read_b64_tr_b16 v[210:211], v3 offset:13248
    v_bfe_u32 v164, v1, 4, 1
    v_lshl_add_u32 v160, v164, 3, v163
    s_waitcnt lgkmcnt(10)
    v_mfma_f32_16x16x32_bf16 v[72:75], v[192:195], v[176:179], v[72:75]
    v_xor_b32 v161, 32, v160
    v_bfe_u32 v163, v1, 3, 2
    v_mfma_f32_16x16x32_bf16 v[76:79], v[192:195], v[180:183], v[76:79]
    ds_read_b64_tr_b16 v[212:213], v4 offset:8896
    ds_read_b64_tr_b16 v[214:215], v4 offset:13248
    v_lshlrev_b32 v163, 4, v163
    v_xor_b32 v163, v163, v23
    v_add_u32 v162, s24, v163
    s_waitcnt lgkmcnt(10)
    v_mfma_f32_16x16x32_bf16 v[80:83], v[196:199], v[176:179], v[80:83]
    s_waitcnt lgkmcnt(6)
    v_max3_f32 v156, v144, v148, v152
    v_max3_f32 v157, v145, v149, v153
    v_mfma_f32_16x16x32_bf16 v[84:87], v[196:199], v[180:183], v[84:87]
    v_sub_f32 v144, v144, v156
    v_sub_f32 v145, v145, v157
    v_sub_f32 v148, v148, v156
    ds_read_b128 v[224:227], v13 offset:0
    v_mfma_f32_16x16x32_bf16 v[88:91], v[200:203], v[176:179], v[88:91]
    v_sub_f32 v149, v149, v157
    v_sub_f32 v152, v152, v156
    v_sub_f32 v153, v153, v157
    ds_read_b128 v[228:231], v13 offset:1024
    v_mfma_f32_16x16x32_bf16 v[92:95], v[200:203], v[180:183], v[92:95]
    v_exp_f32 v144, v144
    v_exp_f32 v145, v145
    v_exp_f32 v148, v148
    ds_read_b128 v[232:235], v13 offset:2048
    s_waitcnt lgkmcnt(7)
    v_mfma_f32_16x16x32_bf16 v[96:99], v[204:207], v[176:179], v[96:99]
    v_exp_f32 v149, v149
    v_exp_f32 v152, v152
    v_exp_f32 v153, v153
    ds_read_b128 v[236:239], v13 offset:3072
    v_mfma_f32_16x16x32_bf16 v[100:103], v[204:207], v[180:183], v[100:103]
    v_mul_f32 v146, v144, v120
    v_mul_f32 v147, v145, v124
    v_fmac_f32 v146, v148, v150
    ds_read_b128 v[240:243], v13 offset:4096
    s_waitcnt lgkmcnt(7)
    v_mfma_f32_16x16x32_bf16 v[104:107], v[208:211], v[176:179], v[104:107]
    v_fmac_f32 v147, v149, v151
    v_fmac_f32 v146, v152, v154
    v_fmac_f32 v147, v153, v155
    ds_read_b128 v[244:247], v13 offset:5120
    v_mfma_f32_16x16x32_bf16 v[108:111], v[208:211], v[180:183], v[108:111]
    v_rcp_f32 v146, v146
    v_rcp_f32 v147, v147
    s_nop 0
    ds_read_b128 v[248:251], v13 offset:6144
    s_waitcnt lgkmcnt(7)
    v_mfma_f32_16x16x32_bf16 v[112:115], v[212:215], v[176:179], v[112:115]
    v_mul_f32 v144, v144, v146
    v_mul_f32 v145, v145, v147
    v_mul_f32 v148, v148, v146
    ds_read_b128 v[252:255], v13 offset:7168
    v_mfma_f32_16x16x32_bf16 v[116:119], v[212:215], v[180:183], v[116:119]
    v_mul_f32 v149, v149, v147
    v_mul_f32 v152, v152, v146
    v_mul_f32 v153, v153, v147
    ds_read_b128 v[24:27], v14 offset:0
    ds_read_b128 v[28:31], v14 offset:1024
    ds_read_b128 v[32:35], v14 offset:2048
    ds_read_b128 v[36:39], v14 offset:3072
    ds_read_b128 v[40:43], v14 offset:4096
    ds_read_b128 v[44:47], v14 offset:5120
    ds_read_b128 v[48:51], v14 offset:6144
    ds_read_b128 v[52:55], v14 offset:7168
    s_waitcnt lgkmcnt(15)
    v_lshlrev_b32 v128, 16, v224
    v_and_b32 v129, 0xffff0000, v224
    v_lshlrev_b32 v130, 16, v225
    v_and_b32 v131, 0xffff0000, v225
    v_lshlrev_b32 v132, 16, v226
    v_and_b32 v133, 0xffff0000, v226
    v_lshlrev_b32 v134, 16, v227
    v_and_b32 v135, 0xffff0000, v227
    s_waitcnt lgkmcnt(7)
    v_lshlrev_b32 v136, 16, v24
    v_and_b32 v137, 0xffff0000, v24
    v_lshlrev_b32 v138, 16, v25
    v_and_b32 v139, 0xffff0000, v25
    v_lshlrev_b32 v140, 16, v26
    v_and_b32 v141, 0xffff0000, v26
    v_lshlrev_b32 v142, 16, v27
    v_and_b32 v143, 0xffff0000, v27
    v_pk_mul_f32 v[56:57], v[56:57], v[144:145] op_sel:[0,0] op_sel_hi:[1,0]
    v_pk_mul_f32 v[58:59], v[58:59], v[144:145] op_sel:[0,0] op_sel_hi:[1,0]
    v_pk_mul_f32 v[60:61], v[60:61], v[144:145] op_sel:[0,1] op_sel_hi:[1,1]
    v_pk_mul_f32 v[62:63], v[62:63], v[144:145] op_sel:[0,1] op_sel_hi:[1,1]
    v_pk_fma_f32 v[56:57], v[128:129], v[148:149], v[56:57] op_sel:[0,0,0] op_sel_hi:[1,0,1]
    v_pk_fma_f32 v[58:59], v[130:131], v[148:149], v[58:59] op_sel:[0,0,0] op_sel_hi:[1,0,1]
    v_pk_fma_f32 v[60:61], v[132:133], v[148:149], v[60:61] op_sel:[0,1,0] op_sel_hi:[1,1,1]
    v_pk_fma_f32 v[62:63], v[134:135], v[148:149], v[62:63] op_sel:[0,1,0] op_sel_hi:[1,1,1]
    v_pk_fma_f32 v[56:57], v[136:137], v[152:153], v[56:57] op_sel:[0,0,0] op_sel_hi:[1,0,1]
    v_pk_fma_f32 v[58:59], v[138:139], v[152:153], v[58:59] op_sel:[0,0,0] op_sel_hi:[1,0,1]
    v_pk_fma_f32 v[60:61], v[140:141], v[152:153], v[60:61] op_sel:[0,1,0] op_sel_hi:[1,1,1]
    v_pk_fma_f32 v[62:63], v[142:143], v[152:153], v[62:63] op_sel:[0,1,0] op_sel_hi:[1,1,1]
    v_lshlrev_b32 v128, 16, v228
    v_and_b32 v129, 0xffff0000, v228
    v_lshlrev_b32 v130, 16, v229
    v_and_b32 v131, 0xffff0000, v229
    v_lshlrev_b32 v132, 16, v230
    v_and_b32 v133, 0xffff0000, v230
    v_lshlrev_b32 v134, 16, v231
    v_and_b32 v135, 0xffff0000, v231
    s_waitcnt lgkmcnt(6)
    v_lshlrev_b32 v136, 16, v28
    v_and_b32 v137, 0xffff0000, v28
    v_lshlrev_b32 v138, 16, v29
    v_and_b32 v139, 0xffff0000, v29
    v_lshlrev_b32 v140, 16, v30
    v_and_b32 v141, 0xffff0000, v30
    v_lshlrev_b32 v142, 16, v31
    v_and_b32 v143, 0xffff0000, v31
    v_pk_mul_f32 v[64:65], v[64:65], v[144:145] op_sel:[0,0] op_sel_hi:[1,0]
    v_pk_mul_f32 v[66:67], v[66:67], v[144:145] op_sel:[0,0] op_sel_hi:[1,0]
    v_pk_mul_f32 v[68:69], v[68:69], v[144:145] op_sel:[0,1] op_sel_hi:[1,1]
    v_pk_mul_f32 v[70:71], v[70:71], v[144:145] op_sel:[0,1] op_sel_hi:[1,1]
    v_pk_fma_f32 v[64:65], v[128:129], v[148:149], v[64:65] op_sel:[0,0,0] op_sel_hi:[1,0,1]
    v_pk_fma_f32 v[66:67], v[130:131], v[148:149], v[66:67] op_sel:[0,0,0] op_sel_hi:[1,0,1]
    v_pk_fma_f32 v[68:69], v[132:133], v[148:149], v[68:69] op_sel:[0,1,0] op_sel_hi:[1,1,1]
    v_pk_fma_f32 v[70:71], v[134:135], v[148:149], v[70:71] op_sel:[0,1,0] op_sel_hi:[1,1,1]
    v_pk_fma_f32 v[64:65], v[136:137], v[152:153], v[64:65] op_sel:[0,0,0] op_sel_hi:[1,0,1]
    v_pk_fma_f32 v[66:67], v[138:139], v[152:153], v[66:67] op_sel:[0,0,0] op_sel_hi:[1,0,1]
    v_pk_fma_f32 v[68:69], v[140:141], v[152:153], v[68:69] op_sel:[0,1,0] op_sel_hi:[1,1,1]
    v_pk_fma_f32 v[70:71], v[142:143], v[152:153], v[70:71] op_sel:[0,1,0] op_sel_hi:[1,1,1]
    v_cvt_pk_bf16_f32 v184, v56, v57
    v_cvt_pk_bf16_f32 v185, v58, v59
    v_cvt_pk_bf16_f32 v186, v64, v65
    v_cvt_pk_bf16_f32 v187, v66, v67
    v_cvt_pk_bf16_f32 v188, v60, v61
    v_cvt_pk_bf16_f32 v189, v62, v63
    v_cvt_pk_bf16_f32 v190, v68, v69
    v_cvt_pk_bf16_f32 v191, v70, v71
    ds_write_b64 v160, v[184:185] offset:0
    ds_write_b64 v161, v[186:187] offset:0
    ds_read_b128 v[184:187], v162 offset:0
    ds_write_b64 v160, v[188:189] offset:1024
    ds_write_b64 v161, v[190:191] offset:1024
    ds_read_b128 v[188:191], v162 offset:1024
    v_lshlrev_b32 v128, 16, v232
    v_and_b32 v129, 0xffff0000, v232
    v_lshlrev_b32 v130, 16, v233
    v_and_b32 v131, 0xffff0000, v233
    v_lshlrev_b32 v132, 16, v234
    v_and_b32 v133, 0xffff0000, v234
    v_lshlrev_b32 v134, 16, v235
    v_and_b32 v135, 0xffff0000, v235
    s_waitcnt lgkmcnt(11)
    v_lshlrev_b32 v136, 16, v32
    v_and_b32 v137, 0xffff0000, v32
    v_lshlrev_b32 v138, 16, v33
    v_and_b32 v139, 0xffff0000, v33
    v_lshlrev_b32 v140, 16, v34
    v_and_b32 v141, 0xffff0000, v34
    v_lshlrev_b32 v142, 16, v35
    v_and_b32 v143, 0xffff0000, v35
    v_pk_mul_f32 v[72:73], v[72:73], v[144:145] op_sel:[0,0] op_sel_hi:[1,0]
    v_pk_mul_f32 v[74:75], v[74:75], v[144:145] op_sel:[0,0] op_sel_hi:[1,0]
    v_pk_mul_f32 v[76:77], v[76:77], v[144:145] op_sel:[0,1] op_sel_hi:[1,1]
    v_pk_mul_f32 v[78:79], v[78:79], v[144:145] op_sel:[0,1] op_sel_hi:[1,1]
    v_pk_fma_f32 v[72:73], v[128:129], v[148:149], v[72:73] op_sel:[0,0,0] op_sel_hi:[1,0,1]
    v_pk_fma_f32 v[74:75], v[130:131], v[148:149], v[74:75] op_sel:[0,0,0] op_sel_hi:[1,0,1]
    v_pk_fma_f32 v[76:77], v[132:133], v[148:149], v[76:77] op_sel:[0,1,0] op_sel_hi:[1,1,1]
    v_pk_fma_f32 v[78:79], v[134:135], v[148:149], v[78:79] op_sel:[0,1,0] op_sel_hi:[1,1,1]
    v_pk_fma_f32 v[72:73], v[136:137], v[152:153], v[72:73] op_sel:[0,0,0] op_sel_hi:[1,0,1]
    v_pk_fma_f32 v[74:75], v[138:139], v[152:153], v[74:75] op_sel:[0,0,0] op_sel_hi:[1,0,1]
    v_pk_fma_f32 v[76:77], v[140:141], v[152:153], v[76:77] op_sel:[0,1,0] op_sel_hi:[1,1,1]
    v_pk_fma_f32 v[78:79], v[142:143], v[152:153], v[78:79] op_sel:[0,1,0] op_sel_hi:[1,1,1]
    s_waitcnt lgkmcnt(3)
    buffer_store_dwordx4 v[184:187], v19, s[40:43], s59 offen offset:0 nt
    v_lshlrev_b32 v128, 16, v236
    v_and_b32 v129, 0xffff0000, v236
    v_lshlrev_b32 v130, 16, v237
    v_and_b32 v131, 0xffff0000, v237
    v_lshlrev_b32 v132, 16, v238
    v_and_b32 v133, 0xffff0000, v238
    v_lshlrev_b32 v134, 16, v239
    v_and_b32 v135, 0xffff0000, v239
    v_lshlrev_b32 v136, 16, v36
    v_and_b32 v137, 0xffff0000, v36
    v_lshlrev_b32 v138, 16, v37
    v_and_b32 v139, 0xffff0000, v37
    v_lshlrev_b32 v140, 16, v38
    v_and_b32 v141, 0xffff0000, v38
    v_lshlrev_b32 v142, 16, v39
    v_and_b32 v143, 0xffff0000, v39
    v_pk_mul_f32 v[80:81], v[80:81], v[144:145] op_sel:[0,0] op_sel_hi:[1,0]
    v_pk_mul_f32 v[82:83], v[82:83], v[144:145] op_sel:[0,0] op_sel_hi:[1,0]
    v_pk_mul_f32 v[84:85], v[84:85], v[144:145] op_sel:[0,1] op_sel_hi:[1,1]
    v_pk_mul_f32 v[86:87], v[86:87], v[144:145] op_sel:[0,1] op_sel_hi:[1,1]
    v_pk_fma_f32 v[80:81], v[128:129], v[148:149], v[80:81] op_sel:[0,0,0] op_sel_hi:[1,0,1]
    v_pk_fma_f32 v[82:83], v[130:131], v[148:149], v[82:83] op_sel:[0,0,0] op_sel_hi:[1,0,1]
    v_pk_fma_f32 v[84:85], v[132:133], v[148:149], v[84:85] op_sel:[0,1,0] op_sel_hi:[1,1,1]
    v_pk_fma_f32 v[86:87], v[134:135], v[148:149], v[86:87] op_sel:[0,1,0] op_sel_hi:[1,1,1]
    v_pk_fma_f32 v[80:81], v[136:137], v[152:153], v[80:81] op_sel:[0,0,0] op_sel_hi:[1,0,1]
    v_pk_fma_f32 v[82:83], v[138:139], v[152:153], v[82:83] op_sel:[0,0,0] op_sel_hi:[1,0,1]
    v_pk_fma_f32 v[84:85], v[140:141], v[152:153], v[84:85] op_sel:[0,1,0] op_sel_hi:[1,1,1]
    v_pk_fma_f32 v[86:87], v[142:143], v[152:153], v[86:87] op_sel:[0,1,0] op_sel_hi:[1,1,1]
    s_waitcnt lgkmcnt(0)
    buffer_store_dwordx4 v[188:191], v19, s[40:43], s58 offen offset:0 nt
    v_cvt_pk_bf16_f32 v192, v72, v73
    v_cvt_pk_bf16_f32 v193, v74, v75
    v_cvt_pk_bf16_f32 v194, v80, v81
    v_cvt_pk_bf16_f32 v195, v82, v83
    v_cvt_pk_bf16_f32 v196, v76, v77
    v_cvt_pk_bf16_f32 v197, v78, v79
    v_cvt_pk_bf16_f32 v198, v84, v85
    v_cvt_pk_bf16_f32 v199, v86, v87
    ds_write_b64 v160, v[192:193] offset:2048
    ds_write_b64 v161, v[194:195] offset:2048
    ds_read_b128 v[192:195], v162 offset:2048
    ds_write_b64 v160, v[196:197] offset:3072
    ds_write_b64 v161, v[198:199] offset:3072
    ds_read_b128 v[196:199], v162 offset:3072
    v_lshlrev_b32 v128, 16, v240
    v_and_b32 v129, 0xffff0000, v240
    v_lshlrev_b32 v130, 16, v241
    v_and_b32 v131, 0xffff0000, v241
    v_lshlrev_b32 v132, 16, v242
    v_and_b32 v133, 0xffff0000, v242
    v_lshlrev_b32 v134, 16, v243
    v_and_b32 v135, 0xffff0000, v243
    v_lshlrev_b32 v136, 16, v40
    v_and_b32 v137, 0xffff0000, v40
    v_lshlrev_b32 v138, 16, v41
    v_and_b32 v139, 0xffff0000, v41
    v_lshlrev_b32 v140, 16, v42
    v_and_b32 v141, 0xffff0000, v42
    v_lshlrev_b32 v142, 16, v43
    v_and_b32 v143, 0xffff0000, v43
    v_pk_mul_f32 v[88:89], v[88:89], v[144:145] op_sel:[0,0] op_sel_hi:[1,0]
    v_pk_mul_f32 v[90:91], v[90:91], v[144:145] op_sel:[0,0] op_sel_hi:[1,0]
    v_pk_mul_f32 v[92:93], v[92:93], v[144:145] op_sel:[0,1] op_sel_hi:[1,1]
    v_pk_mul_f32 v[94:95], v[94:95], v[144:145] op_sel:[0,1] op_sel_hi:[1,1]
    v_pk_fma_f32 v[88:89], v[128:129], v[148:149], v[88:89] op_sel:[0,0,0] op_sel_hi:[1,0,1]
    v_pk_fma_f32 v[90:91], v[130:131], v[148:149], v[90:91] op_sel:[0,0,0] op_sel_hi:[1,0,1]
    v_pk_fma_f32 v[92:93], v[132:133], v[148:149], v[92:93] op_sel:[0,1,0] op_sel_hi:[1,1,1]
    v_pk_fma_f32 v[94:95], v[134:135], v[148:149], v[94:95] op_sel:[0,1,0] op_sel_hi:[1,1,1]
    v_pk_fma_f32 v[88:89], v[136:137], v[152:153], v[88:89] op_sel:[0,0,0] op_sel_hi:[1,0,1]
    v_pk_fma_f32 v[90:91], v[138:139], v[152:153], v[90:91] op_sel:[0,0,0] op_sel_hi:[1,0,1]
    v_pk_fma_f32 v[92:93], v[140:141], v[152:153], v[92:93] op_sel:[0,1,0] op_sel_hi:[1,1,1]
    v_pk_fma_f32 v[94:95], v[142:143], v[152:153], v[94:95] op_sel:[0,1,0] op_sel_hi:[1,1,1]
    s_waitcnt lgkmcnt(3)
    buffer_store_dwordx4 v[192:195], v19, s[40:43], s59 offen offset:64 nt
    v_lshlrev_b32 v128, 16, v244
    v_and_b32 v129, 0xffff0000, v244
    v_lshlrev_b32 v130, 16, v245
    v_and_b32 v131, 0xffff0000, v245
    v_lshlrev_b32 v132, 16, v246
    v_and_b32 v133, 0xffff0000, v246
    v_lshlrev_b32 v134, 16, v247
    v_and_b32 v135, 0xffff0000, v247
    v_lshlrev_b32 v136, 16, v44
    v_and_b32 v137, 0xffff0000, v44
    v_lshlrev_b32 v138, 16, v45
    v_and_b32 v139, 0xffff0000, v45
    v_lshlrev_b32 v140, 16, v46
    v_and_b32 v141, 0xffff0000, v46
    v_lshlrev_b32 v142, 16, v47
    v_and_b32 v143, 0xffff0000, v47
    v_pk_mul_f32 v[96:97], v[96:97], v[144:145] op_sel:[0,0] op_sel_hi:[1,0]
    v_pk_mul_f32 v[98:99], v[98:99], v[144:145] op_sel:[0,0] op_sel_hi:[1,0]
    v_pk_mul_f32 v[100:101], v[100:101], v[144:145] op_sel:[0,1] op_sel_hi:[1,1]
    v_pk_mul_f32 v[102:103], v[102:103], v[144:145] op_sel:[0,1] op_sel_hi:[1,1]
    v_pk_fma_f32 v[96:97], v[128:129], v[148:149], v[96:97] op_sel:[0,0,0] op_sel_hi:[1,0,1]
    v_pk_fma_f32 v[98:99], v[130:131], v[148:149], v[98:99] op_sel:[0,0,0] op_sel_hi:[1,0,1]
    v_pk_fma_f32 v[100:101], v[132:133], v[148:149], v[100:101] op_sel:[0,1,0] op_sel_hi:[1,1,1]
    v_pk_fma_f32 v[102:103], v[134:135], v[148:149], v[102:103] op_sel:[0,1,0] op_sel_hi:[1,1,1]
    v_pk_fma_f32 v[96:97], v[136:137], v[152:153], v[96:97] op_sel:[0,0,0] op_sel_hi:[1,0,1]
    v_pk_fma_f32 v[98:99], v[138:139], v[152:153], v[98:99] op_sel:[0,0,0] op_sel_hi:[1,0,1]
    v_pk_fma_f32 v[100:101], v[140:141], v[152:153], v[100:101] op_sel:[0,1,0] op_sel_hi:[1,1,1]
    v_pk_fma_f32 v[102:103], v[142:143], v[152:153], v[102:103] op_sel:[0,1,0] op_sel_hi:[1,1,1]
    s_waitcnt lgkmcnt(0)
    buffer_store_dwordx4 v[196:199], v19, s[40:43], s58 offen offset:64 nt
    v_cvt_pk_bf16_f32 v200, v88, v89
    v_cvt_pk_bf16_f32 v201, v90, v91
    v_cvt_pk_bf16_f32 v202, v96, v97
    v_cvt_pk_bf16_f32 v203, v98, v99
    v_cvt_pk_bf16_f32 v204, v92, v93
    v_cvt_pk_bf16_f32 v205, v94, v95
    v_cvt_pk_bf16_f32 v206, v100, v101
    v_cvt_pk_bf16_f32 v207, v102, v103
    ds_write_b64 v160, v[200:201] offset:4096
    ds_write_b64 v161, v[202:203] offset:4096
    ds_read_b128 v[200:203], v162 offset:4096
    ds_write_b64 v160, v[204:205] offset:5120
    ds_write_b64 v161, v[206:207] offset:5120
    ds_read_b128 v[204:207], v162 offset:5120
    v_lshlrev_b32 v128, 16, v248
    v_and_b32 v129, 0xffff0000, v248
    v_lshlrev_b32 v130, 16, v249
    v_and_b32 v131, 0xffff0000, v249
    v_lshlrev_b32 v132, 16, v250
    v_and_b32 v133, 0xffff0000, v250
    v_lshlrev_b32 v134, 16, v251
    v_and_b32 v135, 0xffff0000, v251
    v_lshlrev_b32 v136, 16, v48
    v_and_b32 v137, 0xffff0000, v48
    v_lshlrev_b32 v138, 16, v49
    v_and_b32 v139, 0xffff0000, v49
    v_lshlrev_b32 v140, 16, v50
    v_and_b32 v141, 0xffff0000, v50
    v_lshlrev_b32 v142, 16, v51
    v_and_b32 v143, 0xffff0000, v51
    v_pk_mul_f32 v[104:105], v[104:105], v[144:145] op_sel:[0,0] op_sel_hi:[1,0]
    v_pk_mul_f32 v[106:107], v[106:107], v[144:145] op_sel:[0,0] op_sel_hi:[1,0]
    v_pk_mul_f32 v[108:109], v[108:109], v[144:145] op_sel:[0,1] op_sel_hi:[1,1]
    v_pk_mul_f32 v[110:111], v[110:111], v[144:145] op_sel:[0,1] op_sel_hi:[1,1]
    v_pk_fma_f32 v[104:105], v[128:129], v[148:149], v[104:105] op_sel:[0,0,0] op_sel_hi:[1,0,1]
    v_pk_fma_f32 v[106:107], v[130:131], v[148:149], v[106:107] op_sel:[0,0,0] op_sel_hi:[1,0,1]
    v_pk_fma_f32 v[108:109], v[132:133], v[148:149], v[108:109] op_sel:[0,1,0] op_sel_hi:[1,1,1]
    v_pk_fma_f32 v[110:111], v[134:135], v[148:149], v[110:111] op_sel:[0,1,0] op_sel_hi:[1,1,1]
    v_pk_fma_f32 v[104:105], v[136:137], v[152:153], v[104:105] op_sel:[0,0,0] op_sel_hi:[1,0,1]
    v_pk_fma_f32 v[106:107], v[138:139], v[152:153], v[106:107] op_sel:[0,0,0] op_sel_hi:[1,0,1]
    v_pk_fma_f32 v[108:109], v[140:141], v[152:153], v[108:109] op_sel:[0,1,0] op_sel_hi:[1,1,1]
    v_pk_fma_f32 v[110:111], v[142:143], v[152:153], v[110:111] op_sel:[0,1,0] op_sel_hi:[1,1,1]
    s_waitcnt lgkmcnt(3)
    buffer_store_dwordx4 v[200:203], v19, s[40:43], s59 offen offset:128 nt
    v_lshlrev_b32 v128, 16, v252
    v_and_b32 v129, 0xffff0000, v252
    v_lshlrev_b32 v130, 16, v253
    v_and_b32 v131, 0xffff0000, v253
    v_lshlrev_b32 v132, 16, v254
    v_and_b32 v133, 0xffff0000, v254
    v_lshlrev_b32 v134, 16, v255
    v_and_b32 v135, 0xffff0000, v255
    v_lshlrev_b32 v136, 16, v52
    v_and_b32 v137, 0xffff0000, v52
    v_lshlrev_b32 v138, 16, v53
    v_and_b32 v139, 0xffff0000, v53
    v_lshlrev_b32 v140, 16, v54
    v_and_b32 v141, 0xffff0000, v54
    v_lshlrev_b32 v142, 16, v55
    v_and_b32 v143, 0xffff0000, v55
    v_pk_mul_f32 v[112:113], v[112:113], v[144:145] op_sel:[0,0] op_sel_hi:[1,0]
    v_pk_mul_f32 v[114:115], v[114:115], v[144:145] op_sel:[0,0] op_sel_hi:[1,0]
    v_pk_mul_f32 v[116:117], v[116:117], v[144:145] op_sel:[0,1] op_sel_hi:[1,1]
    v_pk_mul_f32 v[118:119], v[118:119], v[144:145] op_sel:[0,1] op_sel_hi:[1,1]
    v_pk_fma_f32 v[112:113], v[128:129], v[148:149], v[112:113] op_sel:[0,0,0] op_sel_hi:[1,0,1]
    v_pk_fma_f32 v[114:115], v[130:131], v[148:149], v[114:115] op_sel:[0,0,0] op_sel_hi:[1,0,1]
    v_pk_fma_f32 v[116:117], v[132:133], v[148:149], v[116:117] op_sel:[0,1,0] op_sel_hi:[1,1,1]
    v_pk_fma_f32 v[118:119], v[134:135], v[148:149], v[118:119] op_sel:[0,1,0] op_sel_hi:[1,1,1]
    v_pk_fma_f32 v[112:113], v[136:137], v[152:153], v[112:113] op_sel:[0,0,0] op_sel_hi:[1,0,1]
    v_pk_fma_f32 v[114:115], v[138:139], v[152:153], v[114:115] op_sel:[0,0,0] op_sel_hi:[1,0,1]
    v_pk_fma_f32 v[116:117], v[140:141], v[152:153], v[116:117] op_sel:[0,1,0] op_sel_hi:[1,1,1]
    v_pk_fma_f32 v[118:119], v[142:143], v[152:153], v[118:119] op_sel:[0,1,0] op_sel_hi:[1,1,1]
    s_waitcnt lgkmcnt(0)
    buffer_store_dwordx4 v[204:207], v19, s[40:43], s58 offen offset:128 nt
    v_cvt_pk_bf16_f32 v208, v104, v105
    v_cvt_pk_bf16_f32 v209, v106, v107
    v_cvt_pk_bf16_f32 v210, v112, v113
    v_cvt_pk_bf16_f32 v211, v114, v115
    v_cvt_pk_bf16_f32 v212, v108, v109
    v_cvt_pk_bf16_f32 v213, v110, v111
    v_cvt_pk_bf16_f32 v214, v116, v117
    v_cvt_pk_bf16_f32 v215, v118, v119
    ds_write_b64 v160, v[208:209] offset:6144
    ds_write_b64 v161, v[210:211] offset:6144
    ds_read_b128 v[208:211], v162 offset:6144
    ds_write_b64 v160, v[212:213] offset:7168
    ds_write_b64 v161, v[214:215] offset:7168
    ds_read_b128 v[212:215], v162 offset:7168
    s_waitcnt lgkmcnt(3)
    buffer_store_dwordx4 v[208:211], v19, s[40:43], s59 offen offset:192 nt
    s_waitcnt lgkmcnt(0)
    buffer_store_dwordx4 v[212:215], v19, s[40:43], s58 offen offset:192 nt
    s_branch L_done
L_solo:
    s_add_u32 s58, s59, 4096
    s_waitcnt lgkmcnt(8)
    v_mfma_f32_16x16x32_bf16 v[120:123], v[8:11], v[176:179], v[120:123]
    s_add_u32 s24, s25, 104448
    v_mfma_f32_16x16x32_bf16 v[124:127], v[8:11], v[180:183], v[124:127]
    v_bfe_u32 v163, v1, 1, 2
    v_mfma_f32_16x16x32_bf16 v[56:59], v[184:187], v[176:179], v[56:59]
    v_lshrrev_b32 v164, 5, v1
    v_mfma_f32_16x16x32_bf16 v[60:63], v[184:187], v[180:183], v[60:63]
    ds_read_b64_tr_b16 v[204:205], v4 offset:8832
    ds_read_b64_tr_b16 v[206:207], v4 offset:13184
    v_xor_b32 v163, v163, v164
    s_waitcnt lgkmcnt(8)
    v_mfma_f32_16x16x32_bf16 v[64:67], v[188:191], v[176:179], v[64:67]
    v_and_b32 v164, 15, v1
    v_lshl_add_u32 v164, v164, 6, s24
    v_lshl_add_u32 v163, v163, 4, v164
    v_mfma_f32_16x16x32_bf16 v[68:71], v[188:191], v[180:183], v[68:71]
    ds_read_b64_tr_b16 v[208:209], v3 offset:8896
    ds_read_b64_tr_b16 v[210:211], v3 offset:13248
    v_bfe_u32 v164, v1, 4, 1
    v_lshl_add_u32 v160, v164, 3, v163
    s_waitcnt lgkmcnt(8)
    v_mfma_f32_16x16x32_bf16 v[72:75], v[192:195], v[176:179], v[72:75]
    v_xor_b32 v161, 32, v160
    v_bfe_u32 v163, v1, 3, 2
    v_mfma_f32_16x16x32_bf16 v[76:79], v[192:195], v[180:183], v[76:79]
    ds_read_b64_tr_b16 v[212:213], v4 offset:8896
    ds_read_b64_tr_b16 v[214:215], v4 offset:13248
    v_lshlrev_b32 v163, 4, v163
    v_xor_b32 v163, v163, v23
    v_add_u32 v162, s24, v163
    s_waitcnt lgkmcnt(8)
    v_mfma_f32_16x16x32_bf16 v[80:83], v[196:199], v[176:179], v[80:83]
    v_mfma_f32_16x16x32_bf16 v[84:87], v[196:199], v[180:183], v[84:87]
    s_waitcnt lgkmcnt(6)
    v_mfma_f32_16x16x32_bf16 v[88:91], v[200:203], v[176:179], v[88:91]
    v_mfma_f32_16x16x32_bf16 v[92:95], v[200:203], v[180:183], v[92:95]
    s_waitcnt lgkmcnt(4)
    v_mfma_f32_16x16x32_bf16 v[96:99], v[204:207], v[176:179], v[96:99]
    v_rcp_f32 v146, v120
    v_mfma_f32_16x16x32_bf16 v[100:103], v[204:207], v[180:183], v[100:103]
    v_rcp_f32 v147, v124
    s_waitcnt lgkmcnt(2)
    v_mfma_f32_16x16x32_bf16 v[104:107], v[208:211], v[176:179], v[104:107]
    v_mfma_f32_16x16x32_bf16 v[108:111], v[208:211], v[180:183], v[108:111]
    s_waitcnt lgkmcnt(0)
    v_mfma_f32_16x16x32_bf16 v[112:115], v[212:215], v[176:179], v[112:115]
    v_mfma_f32_16x16x32_bf16 v[116:119], v[212:215], v[180:183], v[116:119]
    v_pk_mul_f32 v[56:57], v[56:57], v[146:147] op_sel:[0,0] op_sel_hi:[1,0]
    v_pk_mul_f32 v[58:59], v[58:59], v[146:147] op_sel:[0,0] op_sel_hi:[1,0]
    v_pk_mul_f32 v[60:61], v[60:61], v[146:147] op_sel:[0,1] op_sel_hi:[1,1]
    v_pk_mul_f32 v[62:63], v[62:63], v[146:147] op_sel:[0,1] op_sel_hi:[1,1]
    v_pk_mul_f32 v[64:65], v[64:65], v[146:147] op_sel:[0,0] op_sel_hi:[1,0]
    v_pk_mul_f32 v[66:67], v[66:67], v[146:147] op_sel:[0,0] op_sel_hi:[1,0]
    v_pk_mul_f32 v[68:69], v[68:69], v[146:147] op_sel:[0,1] op_sel_hi:[1,1]
    v_pk_mul_f32 v[70:71], v[70:71], v[146:147] op_sel:[0,1] op_sel_hi:[1,1]
    v_cvt_pk_bf16_f32 v184, v56, v57
    v_cvt_pk_bf16_f32 v185, v58, v59
    v_cvt_pk_bf16_f32 v186, v64, v65
    v_cvt_pk_bf16_f32 v187, v66, v67
    v_cvt_pk_bf16_f32 v188, v60, v61
    v_cvt_pk_bf16_f32 v189, v62, v63
    v_cvt_pk_bf16_f32 v190, v68, v69
    v_cvt_pk_bf16_f32 v191, v70, v71
    ds_write_b64 v160, v[184:185] offset:0
    ds_write_b64 v161, v[186:187] offset:0
    ds_read_b128 v[184:187], v162 offset:0
    ds_write_b64 v160, v[188:189] offset:1024
    ds_write_b64 v161, v[190:191] offset:1024
    ds_read_b128 v[188:191], v162 offset:1024
    v_pk_mul_f32 v[72:73], v[72:73], v[146:147] op_sel:[0,0] op_sel_hi:[1,0]
    v_pk_mul_f32 v[74:75], v[74:75], v[146:147] op_sel:[0,0] op_sel_hi:[1,0]
    v_pk_mul_f32 v[76:77], v[76:77], v[146:147] op_sel:[0,1] op_sel_hi:[1,1]
    v_pk_mul_f32 v[78:79], v[78:79], v[146:147] op_sel:[0,1] op_sel_hi:[1,1]
    v_pk_mul_f32 v[80:81], v[80:81], v[146:147] op_sel:[0,0] op_sel_hi:[1,0]
    v_pk_mul_f32 v[82:83], v[82:83], v[146:147] op_sel:[0,0] op_sel_hi:[1,0]
    v_pk_mul_f32 v[84:85], v[84:85], v[146:147] op_sel:[0,1] op_sel_hi:[1,1]
    v_pk_mul_f32 v[86:87], v[86:87], v[146:147] op_sel:[0,1] op_sel_hi:[1,1]
    s_waitcnt lgkmcnt(3)
    buffer_store_dwordx4 v[184:187], v19, s[40:43], s59 offen offset:0 nt
    s_waitcnt lgkmcnt(0)
    buffer_store_dwordx4 v[188:191], v19, s[40:43], s58 offen offset:0 nt
    v_cvt_pk_bf16_f32 v192, v72, v73
    v_cvt_pk_bf16_f32 v193, v74, v75
    v_cvt_pk_bf16_f32 v194, v80, v81
    v_cvt_pk_bf16_f32 v195, v82, v83
    v_cvt_pk_bf16_f32 v196, v76, v77
    v_cvt_pk_bf16_f32 v197, v78, v79
    v_cvt_pk_bf16_f32 v198, v84, v85
    v_cvt_pk_bf16_f32 v199, v86, v87
    ds_write_b64 v160, v[192:193] offset:2048
    ds_write_b64 v161, v[194:195] offset:2048
    ds_read_b128 v[192:195], v162 offset:2048
    ds_write_b64 v160, v[196:197] offset:3072
    ds_write_b64 v161, v[198:199] offset:3072
    ds_read_b128 v[196:199], v162 offset:3072
    v_pk_mul_f32 v[88:89], v[88:89], v[146:147] op_sel:[0,0] op_sel_hi:[1,0]
    v_pk_mul_f32 v[90:91], v[90:91], v[146:147] op_sel:[0,0] op_sel_hi:[1,0]
    v_pk_mul_f32 v[92:93], v[92:93], v[146:147] op_sel:[0,1] op_sel_hi:[1,1]
    v_pk_mul_f32 v[94:95], v[94:95], v[146:147] op_sel:[0,1] op_sel_hi:[1,1]
    v_pk_mul_f32 v[96:97], v[96:97], v[146:147] op_sel:[0,0] op_sel_hi:[1,0]
    v_pk_mul_f32 v[98:99], v[98:99], v[146:147] op_sel:[0,0] op_sel_hi:[1,0]
    v_pk_mul_f32 v[100:101], v[100:101], v[146:147] op_sel:[0,1] op_sel_hi:[1,1]
    v_pk_mul_f32 v[102:103], v[102:103], v[146:147] op_sel:[0,1] op_sel_hi:[1,1]
    s_waitcnt lgkmcnt(3)
    buffer_store_dwordx4 v[192:195], v19, s[40:43], s59 offen offset:64 nt
    s_waitcnt lgkmcnt(0)
    buffer_store_dwordx4 v[196:199], v19, s[40:43], s58 offen offset:64 nt
    v_cvt_pk_bf16_f32 v200, v88, v89
    v_cvt_pk_bf16_f32 v201, v90, v91
    v_cvt_pk_bf16_f32 v202, v96, v97
    v_cvt_pk_bf16_f32 v203, v98, v99
    v_cvt_pk_bf16_f32 v204, v92, v93
    v_cvt_pk_bf16_f32 v205, v94, v95
    v_cvt_pk_bf16_f32 v206, v100, v101
    v_cvt_pk_bf16_f32 v207, v102, v103
    ds_write_b64 v160, v[200:201] offset:4096
    ds_write_b64 v161, v[202:203] offset:4096
    ds_read_b128 v[200:203], v162 offset:4096
    ds_write_b64 v160, v[204:205] offset:5120
    ds_write_b64 v161, v[206:207] offset:5120
    ds_read_b128 v[204:207], v162 offset:5120
    v_pk_mul_f32 v[104:105], v[104:105], v[146:147] op_sel:[0,0] op_sel_hi:[1,0]
    v_pk_mul_f32 v[106:107], v[106:107], v[146:147] op_sel:[0,0] op_sel_hi:[1,0]
    v_pk_mul_f32 v[108:109], v[108:109], v[146:147] op_sel:[0,1] op_sel_hi:[1,1]
    v_pk_mul_f32 v[110:111], v[110:111], v[146:147] op_sel:[0,1] op_sel_hi:[1,1]
    v_pk_mul_f32 v[112:113], v[112:113], v[146:147] op_sel:[0,0] op_sel_hi:[1,0]
    v_pk_mul_f32 v[114:115], v[114:115], v[146:147] op_sel:[0,0] op_sel_hi:[1,0]
    v_pk_mul_f32 v[116:117], v[116:117], v[146:147] op_sel:[0,1] op_sel_hi:[1,1]
    v_pk_mul_f32 v[118:119], v[118:119], v[146:147] op_sel:[0,1] op_sel_hi:[1,1]
    s_waitcnt lgkmcnt(3)
    buffer_store_dwordx4 v[200:203], v19, s[40:43], s59 offen offset:128 nt
    s_waitcnt lgkmcnt(0)
    buffer_store_dwordx4 v[204:207], v19, s[40:43], s58 offen offset:128 nt
    v_cvt_pk_bf16_f32 v208, v104, v105
    v_cvt_pk_bf16_f32 v209, v106, v107
    v_cvt_pk_bf16_f32 v210, v112, v113
    v_cvt_pk_bf16_f32 v211, v114, v115
    v_cvt_pk_bf16_f32 v212, v108, v109
    v_cvt_pk_bf16_f32 v213, v110, v111
    v_cvt_pk_bf16_f32 v214, v116, v117
    v_cvt_pk_bf16_f32 v215, v118, v119
    ds_write_b64 v160, v[208:209] offset:6144
    ds_write_b64 v161, v[210:211] offset:6144
    ds_read_b128 v[208:211], v162 offset:6144
    ds_write_b64 v160, v[212:213] offset:7168
    ds_write_b64 v161, v[214:215] offset:7168
    ds_read_b128 v[212:215], v162 offset:7168
    s_waitcnt lgkmcnt(3)
    buffer_store_dwordx4 v[208:211], v19, s[40:43], s59 offen offset:192 nt
    s_waitcnt lgkmcnt(0)
    buffer_store_dwordx4 v[212:215], v19, s[40:43], s58 offen offset:192 nt
    s_branch L_done
L_helper:
    s_waitcnt vmcnt(1)
    v_readfirstlane_b32 s24, v221
    s_lshl_b32 s69, s20, 10
    s_add_u32 s69, s69, s55
    s_add_u32 s69, s69, 32768
    s_lshr_b32 s24, s24, s91
    s_and_b32 s24, s24, 15
    s_cmp_eq_u32 s24, s89
    s_cbranch_scc0 L_hslow
    s_add_u32 s58, s56, 4096
    s_waitcnt lgkmcnt(8)
    v_mfma_f32_16x16x32_bf16 v[120:123], v[8:11], v[176:179], v[120:123]
    s_lshl_b32 s24, s66, 7
    v_mfma_f32_16x16x32_bf16 v[124:127], v[8:11], v[180:183], v[124:127]
    s_lshl3_add_u32 s24, s20, s24
    v_mfma_f32_16x16x32_bf16 v[56:59], v[184:187], v[176:179], v[56:59]
    s_lshl1_add_u32 s24, s23, s24
    v_mfma_f32_16x16x32_bf16 v[60:63], v[184:187], v[180:183], v[60:63]
    ds_read_b64_tr_b16 v[204:205], v4 offset:8832
    ds_read_b64_tr_b16 v[206:207], v4 offset:13184
    s_add_u32 s24, s24, 33554432
    s_waitcnt lgkmcnt(8)
    v_mfma_f32_16x16x32_bf16 v[64:67], v[188:191], v[176:179], v[64:67]
    v_mov_b32 v13, 1
    v_mfma_f32_16x16x32_bf16 v[68:71], v[188:191], v[180:183], v[68:71]
    ds_read_b64_tr_b16 v[208:209], v3 offset:8896
    ds_read_b64_tr_b16 v[210:211], v3 offset:13248
    s_nop 0
    s_waitcnt lgkmcnt(8)
    v_mfma_f32_16x16x32_bf16 v[72:75], v[192:195], v[176:179], v[72:75]
    v_mov_b32 v146, v120
    v_mfma_f32_16x16x32_bf16 v[76:79], v[192:195], v[180:183], v[76:79]
    ds_read_b64_tr_b16 v[212:213], v4 offset:8896
    ds_read_b64_tr_b16 v[214:215], v4 offset:13248
    v_mov_b32 v147, v124
    v_cvt_pk_bf16_f32 v224, v56, v57
    v_cvt_pk_bf16_f32 v225, v58, v59
    v_cvt_pk_bf16_f32 v226, v60, v61
    v_cvt_pk_bf16_f32 v227, v62, v63
    buffer_store_dwordx4 v[224:227], v23, s[44:47], s56 offen offset:0
    s_waitcnt lgkmcnt(8)
    v_mfma_f32_16x16x32_bf16 v[80:83], v[196:199], v[176:179], v[80:83]
    v_mfma_f32_16x16x32_bf16 v[84:87], v[196:199], v[180:183], v[84:87]
    s_mov_b64 exec, 0xffff
    buffer_store_dwordx4 v[144:147], v23, s[28:31], s69 offen
    s_mov_b64 exec, -1
    v_cvt_pk_bf16_f32 v228, v64, v65
    v_cvt_pk_bf16_f32 v229, v66, v67
    v_cvt_pk_bf16_f32 v230, v68, v69
    v_cvt_pk_bf16_f32 v231, v70, v71
    buffer_store_dwordx4 v[228:231], v23, s[44:47], s56 offen offset:1024
    s_waitcnt lgkmcnt(6)
    v_mfma_f32_16x16x32_bf16 v[88:91], v[200:203], v[176:179], v[88:91]
    v_mfma_f32_16x16x32_bf16 v[92:95], v[200:203], v[180:183], v[92:95]
    v_cvt_pk_bf16_f32 v232, v72, v73
    v_cvt_pk_bf16_f32 v233, v74, v75
    v_cvt_pk_bf16_f32 v234, v76, v77
    v_cvt_pk_bf16_f32 v235, v78, v79
    buffer_store_dwordx4 v[232:235], v23, s[44:47], s56 offen offset:2048
    s_waitcnt lgkmcnt(4)
    v_mfma_f32_16x16x32_bf16 v[96:99], v[204:207], v[176:179], v[96:99]
    v_mfma_f32_16x16x32_bf16 v[100:103], v[204:207], v[180:183], v[100:103]
    v_cvt_pk_bf16_f32 v236, v80, v81
    v_cvt_pk_bf16_f32 v237, v82, v83
    v_cvt_pk_bf16_f32 v238, v84, v85
    v_cvt_pk_bf16_f32 v239, v86, v87
    buffer_store_dwordx4 v[236:239], v23, s[44:47], s56 offen offset:3072
    s_waitcnt lgkmcnt(2)
    v_mfma_f32_16x16x32_bf16 v[104:107], v[208:211], v[176:179], v[104:107]
    v_mfma_f32_16x16x32_bf16 v[108:111], v[208:211], v[180:183], v[108:111]
    v_cvt_pk_bf16_f32 v240, v88, v89
    v_cvt_pk_bf16_f32 v241, v90, v91
    v_cvt_pk_bf16_f32 v242, v92, v93
    v_cvt_pk_bf16_f32 v243, v94, v95
    buffer_store_dwordx4 v[240:243], v23, s[44:47], s58 offen offset:0
    s_waitcnt lgkmcnt(0)
    v_mfma_f32_16x16x32_bf16 v[112:115], v[212:215], v[176:179], v[112:115]
    v_mfma_f32_16x16x32_bf16 v[116:119], v[212:215], v[180:183], v[116:119]
    v_cvt_pk_bf16_f32 v244, v96, v97
    v_cvt_pk_bf16_f32 v245, v98, v99
    v_cvt_pk_bf16_f32 v246, v100, v101
    v_cvt_pk_bf16_f32 v247, v102, v103
    buffer_store_dwordx4 v[244:247], v23, s[44:47], s58 offen offset:1024
    v_cvt_pk_bf16_f32 v248, v104, v105
    v_cvt_pk_bf16_f32 v249, v106, v107
    v_cvt_pk_bf16_f32 v250, v108, v109
    v_cvt_pk_bf16_f32 v251, v110, v111
    buffer_store_dwordx4 v[248:251], v23, s[44:47], s58 offen offset:2048
    s_nop 2
    v_cvt_pk_bf16_f32 v252, v112, v113
    v_cvt_pk_bf16_f32 v253, v114, v115
    v_cvt_pk_bf16_f32 v254, v116, v117
    v_cvt_pk_bf16_f32 v255, v118, v119
    buffer_store_dwordx4 v[252:255], v23, s[44:47], s58 offen offset:3072
    s_mov_b64 exec, 1
    s_waitcnt vmcnt(0)
    buffer_store_dword v13, v220, s[28:31], s24 offen
    s_branch L_hx
L_hslow:
    s_add_u32 s69, s69, 16777216
    s_add_u32 s56, s55, s25
    s_add_u32 s56, s56, 16777216
    s_add_u32 s58, s56, 4096
    s_waitcnt lgkmcnt(8)
    v_mfma_f32_16x16x32_bf16 v[120:123], v[8:11], v[176:179], v[120:123]
    s_lshr_b32 s24, s23, 1
    v_mfma_f32_16x16x32_bf16 v[124:127], v[8:11], v[180:183], v[124:127]
    s_lshl1_add_u32 s24, s20, s24
    v_mfma_f32_16x16x32_bf16 v[56:59], v[184:187], v[176:179], v[56:59]
    s_add_u32 s24, s24, s91
    v_mfma_f32_16x16x32_bf16 v[60:63], v[184:187], v[180:183], v[60:63]
    ds_read_b64_tr_b16 v[204:205], v4 offset:8832
    ds_read_b64_tr_b16 v[206:207], v4 offset:13184
    s_lshl_b32 s24, 16, s24
    s_waitcnt lgkmcnt(8)
    v_mfma_f32_16x16x32_bf16 v[64:67], v[188:191], v[176:179], v[64:67]
    v_mov_b32 v13, s24
    v_mfma_f32_16x16x32_bf16 v[68:71], v[188:191], v[180:183], v[68:71]
    ds_read_b64_tr_b16 v[208:209], v3 offset:8896
    ds_read_b64_tr_b16 v[210:211], v3 offset:13248
    s_nop 0
    s_waitcnt lgkmcnt(8)
    v_mfma_f32_16x16x32_bf16 v[72:75], v[192:195], v[176:179], v[72:75]
    v_mov_b32 v146, v120
    v_mfma_f32_16x16x32_bf16 v[76:79], v[192:195], v[180:183], v[76:79]
    ds_read_b64_tr_b16 v[212:213], v4 offset:8896
    ds_read_b64_tr_b16 v[214:215], v4 offset:13248
    v_mov_b32 v147, v124
    v_cvt_pk_bf16_f32 v224, v56, v57
    v_cvt_pk_bf16_f32 v225, v58, v59
    v_cvt_pk_bf16_f32 v226, v60, v61
    v_cvt_pk_bf16_f32 v227, v62, v63
    buffer_store_dwordx4 v[224:227], v23, s[28:31], s56 offen offset:0 sc1
    s_waitcnt lgkmcnt(8)
    v_mfma_f32_16x16x32_bf16 v[80:83], v[196:199], v[176:179], v[80:83]
    v_mfma_f32_16x16x32_bf16 v[84:87], v[196:199], v[180:183], v[84:87]
    s_mov_b64 exec, 0xffff
    buffer_store_dwordx4 v[144:147], v23, s[28:31], s69 offen sc1
    s_mov_b64 exec, -1
    v_cvt_pk_bf16_f32 v228, v64, v65
    v_cvt_pk_bf16_f32 v229, v66, v67
    v_cvt_pk_bf16_f32 v230, v68, v69
    v_cvt_pk_bf16_f32 v231, v70, v71
    buffer_store_dwordx4 v[228:231], v23, s[28:31], s56 offen offset:1024 sc1
    s_waitcnt lgkmcnt(6)
    v_mfma_f32_16x16x32_bf16 v[88:91], v[200:203], v[176:179], v[88:91]
    v_mfma_f32_16x16x32_bf16 v[92:95], v[200:203], v[180:183], v[92:95]
    v_cvt_pk_bf16_f32 v232, v72, v73
    v_cvt_pk_bf16_f32 v233, v74, v75
    v_cvt_pk_bf16_f32 v234, v76, v77
    v_cvt_pk_bf16_f32 v235, v78, v79
    buffer_store_dwordx4 v[232:235], v23, s[28:31], s56 offen offset:2048 sc1
    s_waitcnt lgkmcnt(4)
    v_mfma_f32_16x16x32_bf16 v[96:99], v[204:207], v[176:179], v[96:99]
    v_mfma_f32_16x16x32_bf16 v[100:103], v[204:207], v[180:183], v[100:103]
    v_cvt_pk_bf16_f32 v236, v80, v81
    v_cvt_pk_bf16_f32 v237, v82, v83
    v_cvt_pk_bf16_f32 v238, v84, v85
    v_cvt_pk_bf16_f32 v239, v86, v87
    buffer_store_dwordx4 v[236:239], v23, s[28:31], s56 offen offset:3072 sc1
    s_waitcnt lgkmcnt(2)
    v_mfma_f32_16x16x32_bf16 v[104:107], v[208:211], v[176:179], v[104:107]
    v_mfma_f32_16x16x32_bf16 v[108:111], v[208:211], v[180:183], v[108:111]
    v_cvt_pk_bf16_f32 v240, v88, v89
    v_cvt_pk_bf16_f32 v241, v90, v91
    v_cvt_pk_bf16_f32 v242, v92, v93
    v_cvt_pk_bf16_f32 v243, v94, v95
    buffer_store_dwordx4 v[240:243], v23, s[28:31], s58 offen offset:0 sc1
    s_waitcnt lgkmcnt(0)
    v_mfma_f32_16x16x32_bf16 v[112:115], v[212:215], v[176:179], v[112:115]
    v_mfma_f32_16x16x32_bf16 v[116:119], v[212:215], v[180:183], v[116:119]
    v_cvt_pk_bf16_f32 v244, v96, v97
    v_cvt_pk_bf16_f32 v245, v98, v99
    v_cvt_pk_bf16_f32 v246, v100, v101
    v_cvt_pk_bf16_f32 v247, v102, v103
    buffer_store_dwordx4 v[244:247], v23, s[28:31], s58 offen offset:1024 sc1
    v_cvt_pk_bf16_f32 v248, v104, v105
    v_cvt_pk_bf16_f32 v249, v106, v107
    v_cvt_pk_bf16_f32 v250, v108, v109
    v_cvt_pk_bf16_f32 v251, v110, v111
    buffer_store_dwordx4 v[248:251], v23, s[28:31], s58 offen offset:2048 sc1
    s_nop 2
    v_cvt_pk_bf16_f32 v252, v112, v113
    v_cvt_pk_bf16_f32 v253, v114, v115
    v_cvt_pk_bf16_f32 v254, v116, v117
    v_cvt_pk_bf16_f32 v255, v118, v119
    buffer_store_dwordx4 v[252:255], v23, s[28:31], s58 offen offset:3072 sc1
    s_mov_b64 exec, 1
    s_waitcnt vmcnt(0)
    buffer_atomic_or v13, v220, s[36:39], s57 offen
L_hx:
    s_mov_b64 exec, -1
    s_cmp_eq_u32 s84, 0
    s_cbranch_scc1 L_done
    s_mov_b32 s48, s84
    s_mov_b32 s49, s85
    s_mov_b32 s50, 1
    s_mov_b32 s51, 3
    s_mov_b32 s23, 2
    s_mov_b32 s22, s86
    s_mov_b32 s26, s87
    s_mov_b32 s60, s88
    s_mov_b32 s84, 0
    s_add_u32 s27, s26, 15
    s_lshr_b32 s27, s27, 4
    s_lshl3_add_u32 s66, s22, s21
    v_mov_b32 v56, 0
    v_mov_b32 v57, 0
    v_mov_b32 v58, 0
    v_mov_b32 v59, 0
    v_mov_b32 v60, 0
    v_mov_b32 v61, 0
    v_mov_b32 v62, 0
    v_mov_b32 v63, 0
    v_mov_b32 v64, 0
    v_mov_b32 v65, 0
    v_mov_b32 v66, 0
    v_mov_b32 v67, 0
    v_mov_b32 v68, 0
    v_mov_b32 v69, 0
    v_mov_b32 v70, 0
    v_mov_b32 v71, 0
    v_mov_b32 v72, 0
    v_mov_b32 v73, 0
    v_mov_b32 v74, 0
    v_mov_b32 v75, 0
    v_mov_b32 v76, 0
    v_mov_b32 v77, 0
    v_mov_b32 v78, 0
    v_mov_b32 v79, 0
    v_mov_b32 v80, 0
    v_mov_b32 v81, 0
    v_mov_b32 v82, 0
    v_mov_b32 v83, 0
    v_mov_b32 v84, 0
    v_mov_b32 v85, 0
    v_mov_b32 v86, 0
    v_mov_b32 v87, 0
    v_mov_b32 v88, 0
    v_mov_b32 v89, 0
    v_mov_b32 v90, 0
    v_mov_b32 v91, 0
    v_mov_b32 v92, 0
    v_mov_b32 v93, 0
    v_mov_b32 v94, 0
    v_mov_b32 v95, 0
    v_mov_b32 v96, 0
    v_mov_b32 v97, 0
    v_mov_b32 v98, 0
    v_mov_b32 v99, 0
    v_mov_b32 v100, 0
    v_mov_b32 v101, 0
    v_mov_b32 v102, 0
    v_mov_b32 v103, 0
    v_mov_b32 v104, 0
    v_mov_b32 v105, 0
    v_mov_b32 v106, 0
    v_mov_b32 v107, 0
    v_mov_b32 v108, 0
    v_mov_b32 v109, 0
    v_mov_b32 v110, 0
    v_mov_b32 v111, 0
    v_mov_b32 v112, 0
    v_mov_b32 v113, 0
    v_mov_b32 v114, 0
    v_mov_b32 v115, 0
    v_mov_b32 v116, 0
    v_mov_b32 v117, 0
    v_mov_b32 v118, 0
    v_mov_b32 v119, 0
    v_mov_b32 v120, 0
    v_mov_b32 v121, 0
    v_mov_b32 v122, 0
    v_mov_b32 v123, 0
    v_mov_b32 v124, 0
    v_mov_b32 v125, 0
    v_mov_b32 v126, 0
    v_mov_b32 v127, 0
    v_mov_b32 v176, 0
    v_mov_b32 v177, 0
    v_mov_b32 v178, 0
    v_mov_b32 v179, 0
    v_mov_b32 v180, 0
    v_mov_b32 v181, 0
    v_mov_b32 v182, 0
    v_mov_b32 v183, 0
    s_branch L_cseg
L_done:
    s_endpgm
L_hooks:
    s_mov_b32 s68, 0
    s_call_b64 s[64:65], L_hook
    s_branch L_loop
L_hook:
    buffer_load_dword v221, v220, s[36:39], s57 offen sc1
    v_lshlrev_b32 v222, 7, v1
    s_lshl_b32 s24, s20, 10
    s_add_u32 s24, s24, s55
    s_add_u32 s24, s24, 32768
    v_add_u32 v222, s24, v222
    s_lshl_b32 s24, s66, 7
    s_add_u32 s24, s24, 33554432
    v_writelane_b32 v222, s24, 2
    s_mov_b64 exec, 7
    buffer_load_dword v223, v222, s[28:31], 0 offen
    s_mov_b64 exec, -1
    s_setpc_b64 s[64:65]
L_order:
    s_mov_b32 s82, 156736
    s_cmp_eq_u32 s20, 6
    s_cbranch_scc1 L_ord6
    s_lshl_b32 s24, s86, 10
    v_lshl_add_u32 v132, v1, 4, s24
    s_cmp_eq_u32 s84, 0
    s_cbranch_scc1 L_ord7
    global_load_dwordx4 v[128:131], v132, s[10:11]
L_ord7:
    s_lshl_b32 s25, s48, 6
    s_lshl_b32 s24, s53, 6
    s_sub_u32 s24, s24, s26
    s_lshr_b32 s24, s24, 6
    s_sub_i32 s24, s25, s24
    s_sub_i32 s24, s24, 108
    s_cmp_eq_u32 s51, 3
    s_cselect_b32 s72, 38, 0
    s_cselect_b32 s78, 32, 0
    s_add_u32 s24, s24, s72
    s_add_u32 s25, s25, s78
    s_cmp_eq_u32 s51, 2
    s_cselect_b32 s72, s83, 0
    s_cmp_lg_u32 s72, 0
    s_cselect_b32 s72, 25, 0
    s_add_u32 s24, s24, s72
    s_lshl_b32 s72, s84, 6
    s_cselect_b32 s78, 204, 0
    s_add_u32 s25, s25, s72
    s_add_u32 s25, s25, s78
    s_add_u32 s25, s25, 38
    s_cmp_eq_u32 s23, 0
    s_cselect_b32 s24, s25, s24
    s_sub_i32 s24, s24, 89
    s_max_i32 s24, s24, 0
    s_lshl_b32 s72, s90, 1
    s_sub_i32 s72, s72, 128
    s_max_i32 s72, s72, 32
    v_cvt_f32_u32 v30, s72
    v_cvt_f32_u32 v31, s24
    v_mul_f32 v32, 0x3e051eb8, v31
    v_sub_f32 v32, v30, v32
    v_mul_f32 v30, 0x3e800000, v30
    v_max_f32 v32, v32, v30
    v_rcp_f32 v32, v32
    v_mul_f32 v31, 0x491228f6, v31
    v_mul_f32 v30, v32, v31
    v_cvt_u32_f32 v30, v30
    s_nop 0
    v_readfirstlane_b32 s81, v30
    s_nop 3
    s_sub_u32 s24, s81, 478412
    s_cmp_lt_u32 s24, 111411
    s_cselect_b32 s24, 7864, 0
    s_add_u32 s81, s81, s24
    s_lshr_b32 s24, s6, 8
    s_add_u32 s24, s24, s21
    s_and_b32 s24, s24, 3
    s_cmp_eq_u32 s24, 1
    s_cselect_b32 s24, 2, 0
    s_sub_i32 s25, s81, 720896
    s_max_i32 s25, s25, 0
    s_mul_i32 s25, s25, s24
    s_add_u32 s81, s81, s25
    s_max_u32 s81, s81, 262144
    s_min_u32 s81, s81, 1048575
    v_writelane_b32 v30, s48, 0
    v_writelane_b32 v30, s51, 1
    v_writelane_b32 v30, s84, 2
    v_writelane_b32 v30, s85, 3
    v_writelane_b32 v30, s86, 4
    v_writelane_b32 v30, s87, 5
    v_writelane_b32 v30, s81, 6
    v_lshlrev_b32 v31, 2, v1
    v_add_u32 v31, 156672, v31
    s_mov_b64 exec, 0xff
    ds_write_b32 v31, v30
    s_mov_b64 exec, -1
    s_waitcnt lgkmcnt(0)
    s_cmp_eq_u32 s84, 0
    s_cbranch_scc1 L_end
    s_mov_b32 s23, 2
    s_mov_b32 s82, 159296
    s_mov_b32 s32, s85
    s_mov_b32 s34, s84
    s_sub_u32 s33, s71, s84
    s_sub_u32 s33, s33, s85
    s_barrier
    s_waitcnt vmcnt(0)
L_ord6:
    s_cmp_eq_u32 s48, 0
    s_cbranch_scc1 L_end
L_sort:
    s_add_u32 s27, s32, s33
    s_add_u32 s27, s27, s34
    s_min_u32 s24, s32, 2
    s_min_u32 s73, s33, 2
    s_sub_u32 s32, s32, s24
    s_sub_u32 s33, s33, s73
    s_add_u32 s73, s32, s33
    s_add_u32 s73, s73, s34
    s_mov_b32 s26, s24
    v_subrev_u32 v132, s24, v1
    v_cmp_gt_u32 s[76:77], s73, v132
    v_mul_u32_u24 v133, 24, v1
    v_add_u32 v133, s82, v133
    v_mov_b32 v134, 0
    v_mov_b32 v135, 0
    ds_write_b64 v133, v[134:135] offset:0
    ds_write_b64 v133, v[134:135] offset:8
    ds_write_b64 v133, v[134:135] offset:16
    v_max3_u32 v134, v128, v129, v130
    v_max_u32 v134, v134, v131
    v_cmp_gt_u32 vcc, 0x1800, v134
    v_lshrrev_b32 v136, 5, v128
    v_lshl_add_u32 v136, v136, 3, s82
    v_lshlrev_b32 v140, v128, 1
    v_lshrrev_b32 v137, 5, v129
    v_lshl_add_u32 v137, v137, 3, s82
    v_lshlrev_b32 v141, v129, 1
    v_lshrrev_b32 v138, 5, v130
    v_lshl_add_u32 v138, v138, 3, s82
    v_lshlrev_b32 v142, v130, 1
    v_lshrrev_b32 v139, 5, v131
    v_lshl_add_u32 v139, v139, 3, s82
    v_lshlrev_b32 v143, v131, 1
    s_and_b64 s[74:75], s[76:77], vcc
    s_mov_b64 exec, s[74:75]
    ds_or_b32 v136, v140
    ds_or_b32 v137, v141
    ds_or_b32 v138, v142
    ds_or_b32 v139, v143
    s_mov_b64 exec, -1
    ds_read_b32 v144, v133 offset:0
    ds_read_b32 v145, v133 offset:8
    ds_read_b32 v146, v133 offset:16
    s_cmp_eq_u32 s23, 2
    s_cselect_b32 s24, s35, 0
    s_cselect_b32 s72, 1, 2
    v_add_u32 v152, s24, v1
    v_subrev_u32 v153, s35, v152
    v_med3_i32 v153, v153, 0, s34
    v_subrev_u32 v154, s72, v152
    v_med3_i32 v154, v154, 0, s33
    s_cmp_eq_u32 s23, 0
    s_cselect_b32 s72, 2, 1
    v_subrev_u32 v152, s72, v152
    v_med3_i32 v152, v152, 0, s32
    v_add3_u32 v152, v152, v153, v154
    v_add_u32 v152, s26, v152
    v_min_u32 v152, 63, v152
    v_lshl_add_u32 v152, v152, 4, s82
    v_lshl_add_u32 v153, v1, 4, s82
    s_lshl4_add_u32 s26, s26, s82
    s_barrier
    s_waitcnt lgkmcnt(0)
    v_bcnt_u32_b32 v144, v144, 0
    v_bcnt_u32_b32 v145, v145, v144
    v_bcnt_u32_b32 v146, v146, v145
    v_mov_b32 v134, v146
    v_add_u32 v140, -1, v140
    v_add_u32 v141, -1, v141
    v_add_u32_dpp v134, v134, v134 row_shr:1 row_mask:0xf bank_mask:0xf
    v_add_u32 v142, -1, v142
    v_add_u32 v143, -1, v143
    v_add_u32_dpp v134, v134, v134 row_shr:2 row_mask:0xf bank_mask:0xf
    v_lshlrev_b32 v128, 15, v128
    v_lshlrev_b32 v129, 15, v129
    v_add_u32_dpp v134, v134, v134 row_shr:4 row_mask:0xf bank_mask:0xf
    v_lshlrev_b32 v130, 15, v130
    v_lshlrev_b32 v131, 15, v131
    v_add_u32_dpp v134, v134, v134 row_shr:8 row_mask:0xf bank_mask:0xf
    s_lshl_b32 s73, s73, 2
    s_nop 0
    v_add_u32_dpp v134, v134, v134 row_bcast:15 row_mask:0xa bank_mask:0xf
    s_nop 0
    s_nop 0
    v_add_u32_dpp v134, v134, v134 row_bcast:31 row_mask:0xc bank_mask:0xf
    v_sub_u32 v135, v134, v146
    v_readlane_b32 s24, v134, 63
    v_add_u32 v144, v144, v135
    v_add_u32 v145, v145, v135
    ds_write_b32 v133, v135 offset:4
    ds_write_b32 v133, v144 offset:12
    ds_write_b32 v133, v145 offset:20
    ds_write_b128 v153, v[128:131] offset:1536
    s_mov_b64 exec, s[74:75]
    ds_read_b64 v[144:145], v136
    ds_read_b64 v[146:147], v137
    ds_read_b64 v[148:149], v138
    ds_read_b64 v[150:151], v139
    s_mov_b64 exec, s[76:77]
    s_cmp_eq_u32 s24, s73
    s_waitcnt lgkmcnt(0)
    v_and_b32 v140, v140, v144
    v_bcnt_u32_b32 v140, v140, v145
    v_and_b32 v141, v141, v146
    v_bcnt_u32_b32 v141, v141, v147
    v_and_b32 v142, v142, v148
    v_bcnt_u32_b32 v142, v142, v149
    v_and_b32 v143, v143, v150
    v_bcnt_u32_b32 v143, v143, v151
    s_cbranch_scc0 L_sortok
    v_lshl_add_u32 v140, v140, 2, s26
    v_lshl_add_u32 v141, v141, 2, s26
    v_lshl_add_u32 v142, v142, 2, s26
    v_lshl_add_u32 v143, v143, 2, s26
    ds_write_b32 v140, v128 offset:1536
    ds_write_b32 v141, v129 offset:1536
    ds_write_b32 v142, v130 offset:1536
    ds_write_b32 v143, v131 offset:1536
L_sortok:
    s_mov_b64 exec, -1
    ds_read_b128 v[128:131], v152 offset:1536
    s_waitcnt lgkmcnt(0)
    ds_write_b128 v153, v[128:131]
    s_waitcnt lgkmcnt(0)
    s_endpgm
L_ann:
    s_lshl_b32 s24, s89, s91
    v_mov_b32 v12, s24
    v_mov_b32 v13, 0
    s_lshr_b32 s24, s66, 1
    s_lshl_b32 s24, s24, 2
    s_mov_b64 exec, 1
    s_waitcnt vmcnt(0)
    buffer_atomic_or v12, v13, s[36:39], s24 offen
    s_mov_b64 exec, -1
    s_branch L_annr
L_mask0:
    v_cmp_lt_i32 vcc, 0, v216
    s_nop 1
    v_cndmask_b32 v128, v217, v128, vcc
    v_cndmask_b32 v132, v217, v132, vcc
    v_cmp_lt_i32 vcc, 4, v216
    s_nop 1
    v_cndmask_b32 v129, v217, v129, vcc
    v_cndmask_b32 v133, v217, v133, vcc
    v_cmp_lt_i32 vcc, 8, v216
    s_nop 1
    v_cndmask_b32 v130, v217, v130, vcc
    v_cndmask_b32 v134, v217, v134, vcc
    v_cmp_lt_i32 vcc, 12, v216
    s_nop 1
    v_cndmask_b32 v131, v217, v131, vcc
    v_cndmask_b32 v135, v217, v135, vcc
    v_cmp_lt_i32 vcc, 16, v216
    s_nop 1
    v_cndmask_b32 v136, v217, v136, vcc
    v_cndmask_b32 v140, v217, v140, vcc
    v_cmp_lt_i32 vcc, 20, v216
    s_nop 1
    v_cndmask_b32 v137, v217, v137, vcc
    v_cndmask_b32 v141, v217, v141, vcc
    v_cmp_lt_i32 vcc, 24, v216
    s_nop 1
    v_cndmask_b32 v138, v217, v138, vcc
    v_cndmask_b32 v142, v217, v142, vcc
    v_cmp_lt_i32 vcc, 28, v216
    s_nop 1
    v_cndmask_b32 v139, v217, v139, vcc
    v_cndmask_b32 v143, v217, v143, vcc
    s_branch L_maskr0
L_mask1:
    v_cmp_lt_i32 vcc, 32, v216
    s_nop 1
    v_cndmask_b32 v144, v217, v144, vcc
    v_cndmask_b32 v148, v217, v148, vcc
    v_cmp_lt_i32 vcc, 36, v216
    s_nop 1
    v_cndmask_b32 v145, v217, v145, vcc
    v_cndmask_b32 v149, v217, v149, vcc
    v_cmp_lt_i32 vcc, 40, v216
    s_nop 1
    v_cndmask_b32 v146, v217, v146, vcc
    v_cndmask_b32 v150, v217, v150, vcc
    v_cmp_lt_i32 vcc, 44, v216
    s_nop 1
    v_cndmask_b32 v147, v217, v147, vcc
    v_cndmask_b32 v151, v217, v151, vcc
    v_cmp_lt_i32 vcc, 48, v216
    s_nop 1
    v_cndmask_b32 v152, v217, v152, vcc
    v_cndmask_b32 v156, v217, v156, vcc
    v_cmp_lt_i32 vcc, 52, v216
    s_nop 1
    v_cndmask_b32 v153, v217, v153, vcc
    v_cndmask_b32 v157, v217, v157, vcc
    v_cmp_lt_i32 vcc, 56, v216
    s_nop 1
    v_cndmask_b32 v154, v217, v154, vcc
    v_cndmask_b32 v158, v217, v158, vcc
    v_cmp_lt_i32 vcc, 60, v216
    s_nop 1
    v_cndmask_b32 v155, v217, v155, vcc
    v_cndmask_b32 v159, v217, v159, vcc
    s_branch L_maskr1
L_fbs1:
    s_call_b64 s[64:65], L_fb0
    s_branch L_fbr1
L_fbs2:
    s_call_b64 s[64:65], L_fb1
    s_branch L_fbr2
L_fbs3:
    s_call_b64 s[64:65], L_fb0
    s_branch L_fbr3
L_fbs4:
    s_call_b64 s[64:65], L_fb1
    s_branch L_fbr4
L_fb0:
    s_nop 7
    v_max3_f32 v216, v128, v129, v130
    v_max3_f32 v216, v216, v131, v136
    v_max3_f32 v216, v216, v137, v138
    v_max_f32 v216, v216, v139
    v_max3_f32 v217, v132, v133, v134
    v_max3_f32 v217, v217, v135, v140
    v_max3_f32 v217, v217, v141, v142
    v_max_f32 v217, v217, v143
    v_mov_b32 v218, v216
    v_mov_b32 v219, v217
    s_nop 0
    v_permlane32_swap_b32 v216, v218
    v_permlane32_swap_b32 v217, v219
    v_max_f32 v216, v216, v218
    v_max_f32 v217, v217, v219
    v_mov_b32 v218, v216
    v_mov_b32 v219, v217
    s_nop 0
    v_permlane16_swap_b32 v216, v218
    v_permlane16_swap_b32 v217, v219
    v_max_f32 v216, v216, v218
    v_max_f32 v217, v217, v219
    v_add_f32 v216, 0x41200000, v216
    v_add_f32 v217, 0x41200000, v217
    v_max_f32 v216, 0, v216
    v_max_f32 v217, 0, v217
    v_sub_f32 v218, 0, v216
    v_sub_f32 v219, 0, v217
    v_exp_f32 v218, v218
    v_exp_f32 v219, v219
    v_sub_f32 v160, v160, v216
    v_sub_f32 v161, v161, v216
    v_sub_f32 v162, v162, v216
    v_sub_f32 v163, v163, v216
    v_sub_f32 v164, v164, v217
    v_sub_f32 v165, v165, v217
    v_sub_f32 v166, v166, v217
    v_sub_f32 v167, v167, v217
    v_sub_f32 v128, v128, v216
    v_sub_f32 v129, v129, v216
    v_sub_f32 v130, v130, v216
    v_sub_f32 v131, v131, v216
    v_sub_f32 v132, v132, v217
    v_sub_f32 v133, v133, v217
    v_sub_f32 v134, v134, v217
    v_sub_f32 v135, v135, v217
    v_sub_f32 v136, v136, v216
    v_sub_f32 v137, v137, v216
    v_sub_f32 v138, v138, v216
    v_sub_f32 v139, v139, v216
    v_sub_f32 v140, v140, v217
    v_sub_f32 v141, v141, v217
    v_sub_f32 v142, v142, v217
    v_sub_f32 v143, v143, v217
    v_sub_f32 v144, v144, v216
    v_sub_f32 v145, v145, v216
    v_sub_f32 v146, v146, v216
    v_sub_f32 v147, v147, v216
    v_sub_f32 v148, v148, v217
    v_sub_f32 v149, v149, v217
    v_sub_f32 v150, v150, v217
    v_sub_f32 v151, v151, v217
    v_sub_f32 v152, v152, v216
    v_sub_f32 v153, v153, v216
    v_sub_f32 v154, v154, v216
    v_sub_f32 v155, v155, v216
    v_sub_f32 v156, v156, v217
    v_sub_f32 v157, v157, v217
    v_sub_f32 v158, v158, v217
    v_sub_f32 v159, v159, v217
    v_mul_f32 v56, v218, v56
    v_mul_f32 v57, v218, v57
    v_mul_f32 v58, v218, v58
    v_mul_f32 v59, v218, v59
    v_mul_f32 v60, v219, v60
    v_mul_f32 v61, v219, v61
    v_mul_f32 v62, v219, v62
    v_mul_f32 v63, v219, v63
    v_mul_f32 v64, v218, v64
    v_mul_f32 v65, v218, v65
    v_mul_f32 v66, v218, v66
    v_mul_f32 v67, v218, v67
    v_mul_f32 v68, v219, v68
    v_mul_f32 v69, v219, v69
    v_mul_f32 v70, v219, v70
    v_mul_f32 v71, v219, v71
    v_mul_f32 v72, v218, v72
    v_mul_f32 v73, v218, v73
    v_mul_f32 v74, v218, v74
    v_mul_f32 v75, v218, v75
    v_mul_f32 v76, v219, v76
    v_mul_f32 v77, v219, v77
    v_mul_f32 v78, v219, v78
    v_mul_f32 v79, v219, v79
    v_mul_f32 v80, v218, v80
    v_mul_f32 v81, v218, v81
    v_mul_f32 v82, v218, v82
    v_mul_f32 v83, v218, v83
    v_mul_f32 v84, v219, v84
    v_mul_f32 v85, v219, v85
    v_mul_f32 v86, v219, v86
    v_mul_f32 v87, v219, v87
    v_mul_f32 v88, v218, v88
    v_mul_f32 v89, v218, v89
    v_mul_f32 v90, v218, v90
    v_mul_f32 v91, v218, v91
    v_mul_f32 v92, v219, v92
    v_mul_f32 v93, v219, v93
    v_mul_f32 v94, v219, v94
    v_mul_f32 v95, v219, v95
    v_mul_f32 v96, v218, v96
    v_mul_f32 v97, v218, v97
    v_mul_f32 v98, v218, v98
    v_mul_f32 v99, v218, v99
    v_mul_f32 v100, v219, v100
    v_mul_f32 v101, v219, v101
    v_mul_f32 v102, v219, v102
    v_mul_f32 v103, v219, v103
    v_mul_f32 v104, v218, v104
    v_mul_f32 v105, v218, v105
    v_mul_f32 v106, v218, v106
    v_mul_f32 v107, v218, v107
    v_mul_f32 v108, v219, v108
    v_mul_f32 v109, v219, v109
    v_mul_f32 v110, v219, v110
    v_mul_f32 v111, v219, v111
    v_mul_f32 v112, v218, v112
    v_mul_f32 v113, v218, v113
    v_mul_f32 v114, v218, v114
    v_mul_f32 v115, v218, v115
    v_mul_f32 v116, v219, v116
    v_mul_f32 v117, v219, v117
    v_mul_f32 v118, v219, v118
    v_mul_f32 v119, v219, v119
    v_mul_f32 v120, v218, v120
    v_mul_f32 v121, v218, v121
    v_mul_f32 v122, v218, v122
    v_mul_f32 v123, v218, v123
    v_mul_f32 v124, v219, v124
    v_mul_f32 v125, v219, v125
    v_mul_f32 v126, v219, v126
    v_mul_f32 v127, v219, v127
    v_exp_f32 v12, v128
    v_exp_f32 v13, v129
    v_exp_f32 v14, v130
    v_exp_f32 v15, v131
    v_cvt_pk_bf16_f32 v168, v12, v13
    v_exp_f32 v16, v132
    v_exp_f32 v17, v133
    v_cvt_pk_bf16_f32 v169, v14, v15
    v_exp_f32 v12, v134
    v_exp_f32 v13, v135
    v_cvt_pk_bf16_f32 v172, v16, v17
    v_or3_b32 v0, v168, v169, v172
    v_exp_f32 v14, v136
    v_exp_f32 v15, v137
    v_cvt_pk_bf16_f32 v173, v12, v13
    v_exp_f32 v16, v138
    v_exp_f32 v17, v139
    v_cvt_pk_bf16_f32 v170, v14, v15
    v_or3_b32 v0, v0, v173, v170
    v_exp_f32 v12, v140
    v_exp_f32 v13, v141
    v_cvt_pk_bf16_f32 v171, v16, v17
    v_exp_f32 v14, v142
    v_exp_f32 v15, v143
    v_cvt_pk_bf16_f32 v174, v12, v13
    v_or3_b32 v0, v0, v171, v174
    v_cvt_pk_bf16_f32 v175, v14, v15
    v_bitop3_b32 v0, v0, v175, s61 bitop3:0xa8
    v_cmp_ne_u32 vcc, 0, v0
    s_nop 1
    s_setpc_b64 s[64:65]
L_fb1:
    s_nop 7
    v_max3_f32 v216, v144, v145, v146
    v_max3_f32 v216, v216, v147, v152
    v_max3_f32 v216, v216, v153, v154
    v_max_f32 v216, v216, v155
    v_max3_f32 v217, v148, v149, v150
    v_max3_f32 v217, v217, v151, v156
    v_max3_f32 v217, v217, v157, v158
    v_max_f32 v217, v217, v159
    v_mov_b32 v218, v216
    v_mov_b32 v219, v217
    s_nop 0
    v_permlane32_swap_b32 v216, v218
    v_permlane32_swap_b32 v217, v219
    v_max_f32 v216, v216, v218
    v_max_f32 v217, v217, v219
    v_mov_b32 v218, v216
    v_mov_b32 v219, v217
    s_nop 0
    v_permlane16_swap_b32 v216, v218
    v_permlane16_swap_b32 v217, v219
    v_max_f32 v216, v216, v218
    v_max_f32 v217, v217, v219
    v_add_f32 v216, 0x41200000, v216
    v_add_f32 v217, 0x41200000, v217
    v_max_f32 v216, 0, v216
    v_max_f32 v217, 0, v217
    v_sub_f32 v218, 0, v216
    v_sub_f32 v219, 0, v217
    v_exp_f32 v218, v218
    v_exp_f32 v219, v219
    v_sub_f32 v160, v160, v216
    v_sub_f32 v161, v161, v216
    v_sub_f32 v162, v162, v216
    v_sub_f32 v163, v163, v216
    v_sub_f32 v164, v164, v217
    v_sub_f32 v165, v165, v217
    v_sub_f32 v166, v166, v217
    v_sub_f32 v167, v167, v217
    v_sub_f32 v144, v144, v216
    v_sub_f32 v145, v145, v216
    v_sub_f32 v146, v146, v216
    v_sub_f32 v147, v147, v216
    v_sub_f32 v148, v148, v217
    v_sub_f32 v149, v149, v217
    v_sub_f32 v150, v150, v217
    v_sub_f32 v151, v151, v217
    v_sub_f32 v152, v152, v216
    v_sub_f32 v153, v153, v216
    v_sub_f32 v154, v154, v216
    v_sub_f32 v155, v155, v216
    v_sub_f32 v156, v156, v217
    v_sub_f32 v157, v157, v217
    v_sub_f32 v158, v158, v217
    v_sub_f32 v159, v159, v217
    v_sub_f32 v128, v128, v216
    v_sub_f32 v129, v129, v216
    v_sub_f32 v130, v130, v216
    v_sub_f32 v131, v131, v216
    v_sub_f32 v132, v132, v217
    v_sub_f32 v133, v133, v217
    v_sub_f32 v134, v134, v217
    v_sub_f32 v135, v135, v217
    v_sub_f32 v136, v136, v216
    v_sub_f32 v137, v137, v216
    v_sub_f32 v138, v138, v216
    v_sub_f32 v139, v139, v216
    v_sub_f32 v140, v140, v217
    v_sub_f32 v141, v141, v217
    v_sub_f32 v142, v142, v217
    v_sub_f32 v143, v143, v217
    v_mul_f32 v56, v218, v56
    v_mul_f32 v57, v218, v57
    v_mul_f32 v58, v218, v58
    v_mul_f32 v59, v218, v59
    v_mul_f32 v60, v219, v60
    v_mul_f32 v61, v219, v61
    v_mul_f32 v62, v219, v62
    v_mul_f32 v63, v219, v63
    v_mul_f32 v64, v218, v64
    v_mul_f32 v65, v218, v65
    v_mul_f32 v66, v218, v66
    v_mul_f32 v67, v218, v67
    v_mul_f32 v68, v219, v68
    v_mul_f32 v69, v219, v69
    v_mul_f32 v70, v219, v70
    v_mul_f32 v71, v219, v71
    v_mul_f32 v72, v218, v72
    v_mul_f32 v73, v218, v73
    v_mul_f32 v74, v218, v74
    v_mul_f32 v75, v218, v75
    v_mul_f32 v76, v219, v76
    v_mul_f32 v77, v219, v77
    v_mul_f32 v78, v219, v78
    v_mul_f32 v79, v219, v79
    v_mul_f32 v80, v218, v80
    v_mul_f32 v81, v218, v81
    v_mul_f32 v82, v218, v82
    v_mul_f32 v83, v218, v83
    v_mul_f32 v84, v219, v84
    v_mul_f32 v85, v219, v85
    v_mul_f32 v86, v219, v86
    v_mul_f32 v87, v219, v87
    v_mul_f32 v88, v218, v88
    v_mul_f32 v89, v218, v89
    v_mul_f32 v90, v218, v90
    v_mul_f32 v91, v218, v91
    v_mul_f32 v92, v219, v92
    v_mul_f32 v93, v219, v93
    v_mul_f32 v94, v219, v94
    v_mul_f32 v95, v219, v95
    v_mul_f32 v96, v218, v96
    v_mul_f32 v97, v218, v97
    v_mul_f32 v98, v218, v98
    v_mul_f32 v99, v218, v99
    v_mul_f32 v100, v219, v100
    v_mul_f32 v101, v219, v101
    v_mul_f32 v102, v219, v102
    v_mul_f32 v103, v219, v103
    v_mul_f32 v104, v218, v104
    v_mul_f32 v105, v218, v105
    v_mul_f32 v106, v218, v106
    v_mul_f32 v107, v218, v107
    v_mul_f32 v108, v219, v108
    v_mul_f32 v109, v219, v109
    v_mul_f32 v110, v219, v110
    v_mul_f32 v111, v219, v111
    v_mul_f32 v112, v218, v112
    v_mul_f32 v113, v218, v113
    v_mul_f32 v114, v218, v114
    v_mul_f32 v115, v218, v115
    v_mul_f32 v116, v219, v116
    v_mul_f32 v117, v219, v117
    v_mul_f32 v118, v219, v118
    v_mul_f32 v119, v219, v119
    v_mul_f32 v120, v218, v120
    v_mul_f32 v121, v218, v121
    v_mul_f32 v122, v218, v122
    v_mul_f32 v123, v218, v123
    v_mul_f32 v124, v219, v124
    v_mul_f32 v125, v219, v125
    v_mul_f32 v126, v219, v126
    v_mul_f32 v127, v219, v127
    v_exp_f32 v12, v144
    v_exp_f32 v13, v145
    v_exp_f32 v14, v146
    v_exp_f32 v15, v147
    v_cvt_pk_bf16_f32 v176, v12, v13
    v_exp_f32 v16, v148
    v_exp_f32 v17, v149
    v_cvt_pk_bf16_f32 v177, v14, v15
    v_exp_f32 v12, v150
    v_exp_f32 v13, v151
    v_cvt_pk_bf16_f32 v180, v16, v17
    v_or3_b32 v0, v176, v177, v180
    v_exp_f32 v14, v152
    v_exp_f32 v15, v153
    v_cvt_pk_bf16_f32 v181, v12, v13
    v_exp_f32 v16, v154
    v_exp_f32 v17, v155
    v_cvt_pk_bf16_f32 v178, v14, v15
    v_or3_b32 v0, v0, v181, v178
    v_exp_f32 v12, v156
    v_exp_f32 v13, v157
    v_cvt_pk_bf16_f32 v179, v16, v17
    v_exp_f32 v14, v158
    v_exp_f32 v15, v159
    v_cvt_pk_bf16_f32 v182, v12, v13
    v_or3_b32 v0, v0, v179, v182
    v_cvt_pk_bf16_f32 v183, v14, v15
    v_bitop3_b32 v0, v0, v183, s61 bitop3:0xa8
    v_cmp_ne_u32 vcc, 0, v0
    s_nop 1
    s_setpc_b64 s[64:65]
.p2align 6
L_aux:
    s_waitcnt lgkmcnt(0)
    v_readlane_b32 s48, v30, 0
    v_readlane_b32 s51, v30, 1
    v_readlane_b32 s84, v30, 2
    v_readlane_b32 s85, v30, 3
    v_readlane_b32 s86, v30, 4
    v_readlane_b32 s87, v30, 5
    v_readlane_b32 s80, v30, 6
    s_mov_b32 s88, 0
    v_min_u32 v4, 134316032, v4
    v_min_u32 v5, 134316032, v5
    s_cmp_eq_u32 s48, 0
    s_cbranch_scc1 L_end
L_nob:
    s_mov_b32 s94, 1
    s_mov_b32 s96, s80
    s_mov_b32 s97, 0x7fff
    s_lshl_b32 s79, s80, 16
    s_lshr_b32 s80, s80, 16
    s_mov_b32 s72, 0x80000000
L_wok:
    s_mov_b32 s62, 1
L_wok2:
    s_mov_b32 s82, 0
    s_sub_u32 s83, s48, 1
    s_cmp_eq_u32 s84, 0
    s_cselect_b32 s24, 0, 0
    s_cmp_eq_u32 s23, 1
    s_cselect_b32 s24, 3, s24
    s_sub_i32 s78, s48, s24
    s_min_i32 s78, s78, s83
    s_mov_b32 s99, s78
    s_min_i32 s78, s78, s97
    s_bfe_u32 s98, s2, 0x20003
    s_add_u32 s98, s98, 0
    s_mul_i32 s24, s2, 0x9e3779b1
    s_lshr_b32 s24, s24, 1
    s_sub_i32 s25, s99, 6
    s_mul_hi_u32 s95, s24, s25
    s_add_u32 s95, s95, 6
    s_mul_i32 s25, s25, s94
    s_mov_b32 s94, 0
    s_cmp_gt_i32 s25, 0
    s_cselect_b32 s98, s98, -1
    s_cselect_b32 s95, s95, 0x7fff
    s_min_i32 s78, s78, s95
    s_cmp_ge_i32 s62, s78
    s_cbranch_scc1 L_wfull
L_disp:
    s_cmp_ge_u32 s80, 9
    s_cbranch_scc1 L_wc2
    s_cmp_eq_u32 s82, 1
    s_cbranch_scc1 L_wc1
    s_waitcnt vmcnt(8)
    s_barrier
    s_mov_b32 s82, 1
L_wc1:
    s_cmp_eq_u32 s80, 8
    s_cbranch_scc1 L_w8
    s_cmp_eq_u32 s80, 7
    s_cbranch_scc1 L_w7
    s_cmp_eq_u32 s80, 6
    s_cbranch_scc1 L_w6
    s_cmp_eq_u32 s80, 5
    s_cbranch_scc1 L_w5
    s_branch L_w4
L_wc2:
    s_cmp_eq_u32 s80, 10
    s_cbranch_scc1 L_w10
    s_cmp_eq_u32 s80, 11
    s_cbranch_scc1 L_w11
    s_cmp_eq_u32 s80, 9
    s_cbranch_scc1 L_w9
    s_cmp_eq_u32 s80, 12
    s_cbranch_scc1 L_w12
    s_cmp_eq_u32 s80, 13
    s_cbranch_scc1 L_w13
    s_cmp_eq_u32 s80, 14
    s_cbranch_scc1 L_w14
    s_branch L_w15
L_wh4:
    s_mov_b32 s55, s44
    s_mov_b32 s56, s45
    v_readlane_b32 s44, v4, s54
    v_readlane_b32 s45, v5, s54
    s_add_u32 s54, s54, 1
    s_nop 0
    s_add_u32 m0, s57, 0
    s_waitcnt vmcnt(4)
    buffer_load_dwordx4 v8, s[32:35], s44 offen offset:0 nt lds
    s_waitcnt vmcnt(4)
    buffer_load_dwordx4 v9, s[32:35], s44 offen offset:1088 nt lds
    s_waitcnt vmcnt(4)
    buffer_load_dwordx4 v10, s[32:35], s44 offen offset:2176 nt lds
    s_waitcnt vmcnt(4)
    buffer_load_dwordx4 v11, s[32:35], s44 offen offset:3264 nt lds
    s_add_u32 m0, s57, 17408
    s_waitcnt vmcnt(4)
    s_sub_u32 s98, s98, 1
    s_cbranch_scc1 L_wskip1
    s_barrier
L_wskip1:
    buffer_load_dwordx4 v12, s[36:39], s55 offen offset:0 nt lds
    s_waitcnt vmcnt(4)
    buffer_load_dwordx4 v13, s[36:39], s55 offen offset:1088 nt lds
    s_waitcnt vmcnt(4)
    buffer_load_dwordx4 v14, s[36:39], s55 offen offset:2176 nt lds
    s_waitcnt vmcnt(4)
    buffer_load_dwordx4 v15, s[36:39], s55 offen offset:3264 nt lds
    s_add_u32 m0, s57, 8704
    s_waitcnt vmcnt(4)
    buffer_load_dwordx4 v8, s[32:35], s45 offen offset:0 nt lds
    s_waitcnt vmcnt(4)
    buffer_load_dwordx4 v9, s[32:35], s45 offen offset:1088 nt lds
    s_waitcnt vmcnt(4)
    buffer_load_dwordx4 v10, s[32:35], s45 offen offset:2176 nt lds
    s_waitcnt vmcnt(4)
    buffer_load_dwordx4 v11, s[32:35], s45 offen offset:3264 nt lds
    s_add_u32 m0, s57, 26112
    s_waitcnt vmcnt(4)
    s_sub_u32 s98, s98, 1
    s_cbranch_scc1 L_wskip2
    s_barrier
L_wskip2:
    buffer_load_dwordx4 v12, s[36:39], s56 offen offset:0 nt lds
    s_waitcnt vmcnt(4)
    buffer_load_dwordx4 v13, s[36:39], s56 offen offset:1088 nt lds
    s_waitcnt vmcnt(4)
    buffer_load_dwordx4 v14, s[36:39], s56 offen offset:2176 nt lds
    s_waitcnt vmcnt(4)
    buffer_load_dwordx4 v15, s[36:39], s56 offen offset:3264 nt lds
    s_add_u32 s57, s57, 34816
    s_cmp_ge_u32 s57, 104448
    s_cselect_b32 s57, s77, s57
    s_add_u32 s62, s62, 1
L_w4:
    s_cmp_ge_i32 s62, s78
    s_cbranch_scc1 L_wfull
    s_add_u32 s72, s72, s79
    s_cbranch_scc1 L_wh4
    s_mov_b32 s55, s44
    s_mov_b32 s56, s45
    v_readlane_b32 s44, v4, s54
    v_readlane_b32 s45, v5, s54
    s_add_u32 s54, s54, 1
    s_nop 0
    s_add_u32 m0, s57, 0
    s_waitcnt vmcnt(3)
    buffer_load_dwordx4 v8, s[32:35], s44 offen offset:0 nt lds
    s_waitcnt vmcnt(3)
    buffer_load_dwordx4 v9, s[32:35], s44 offen offset:1088 nt lds
    s_waitcnt vmcnt(3)
    buffer_load_dwordx4 v10, s[32:35], s44 offen offset:2176 nt lds
    s_waitcnt vmcnt(3)
    s_sub_u32 s98, s98, 1
    s_cbranch_scc1 L_wskip3
    s_barrier
L_wskip3:
    buffer_load_dwordx4 v11, s[32:35], s44 offen offset:3264 nt lds
    s_add_u32 m0, s57, 17408
    s_waitcnt vmcnt(3)
    buffer_load_dwordx4 v12, s[36:39], s55 offen offset:0 nt lds
    s_waitcnt vmcnt(3)
    buffer_load_dwordx4 v13, s[36:39], s55 offen offset:1088 nt lds
    s_waitcnt vmcnt(3)
    buffer_load_dwordx4 v14, s[36:39], s55 offen offset:2176 nt lds
    s_waitcnt vmcnt(3)
    buffer_load_dwordx4 v15, s[36:39], s55 offen offset:3264 nt lds
    s_add_u32 m0, s57, 8704
    s_waitcnt vmcnt(3)
    buffer_load_dwordx4 v8, s[32:35], s45 offen offset:0 nt lds
    s_waitcnt vmcnt(3)
    buffer_load_dwordx4 v9, s[32:35], s45 offen offset:1088 nt lds
    s_waitcnt vmcnt(3)
    buffer_load_dwordx4 v10, s[32:35], s45 offen offset:2176 nt lds
    s_waitcnt vmcnt(3)
    s_sub_u32 s98, s98, 1
    s_cbranch_scc1 L_wskip4
    s_barrier
L_wskip4:
    buffer_load_dwordx4 v11, s[32:35], s45 offen offset:3264 nt lds
    s_add_u32 m0, s57, 26112
    s_waitcnt vmcnt(3)
    buffer_load_dwordx4 v12, s[36:39], s56 offen offset:0 nt lds
    s_waitcnt vmcnt(3)
    buffer_load_dwordx4 v13, s[36:39], s56 offen offset:1088 nt lds
    s_waitcnt vmcnt(3)
    buffer_load_dwordx4 v14, s[36:39], s56 offen offset:2176 nt lds
    s_waitcnt vmcnt(3)
    buffer_load_dwordx4 v15, s[36:39], s56 offen offset:3264 nt lds
    s_add_u32 s57, s57, 34816
    s_cmp_ge_u32 s57, 104448
    s_cselect_b32 s57, s77, s57
    s_add_u32 s62, s62, 1
    s_branch L_w4
L_wh5:
    s_mov_b32 s55, s44
    s_mov_b32 s56, s45
    v_readlane_b32 s44, v4, s54
    v_readlane_b32 s45, v5, s54
    s_add_u32 s54, s54, 1
    s_nop 0
    s_add_u32 m0, s57, 0
    s_waitcnt vmcnt(5)
    buffer_load_dwordx4 v8, s[32:35], s44 offen offset:0 nt lds
    s_waitcnt vmcnt(5)
    buffer_load_dwordx4 v9, s[32:35], s44 offen offset:1088 nt lds
    s_waitcnt vmcnt(5)
    buffer_load_dwordx4 v10, s[32:35], s44 offen offset:2176 nt lds
    s_waitcnt vmcnt(5)
    buffer_load_dwordx4 v11, s[32:35], s44 offen offset:3264 nt lds
    s_add_u32 m0, s57, 17408
    s_waitcnt vmcnt(5)
    buffer_load_dwordx4 v12, s[36:39], s55 offen offset:0 nt lds
    s_waitcnt vmcnt(5)
    s_sub_u32 s98, s98, 1
    s_cbranch_scc1 L_wskip5
    s_barrier
L_wskip5:
    buffer_load_dwordx4 v13, s[36:39], s55 offen offset:1088 nt lds
    s_waitcnt vmcnt(5)
    buffer_load_dwordx4 v14, s[36:39], s55 offen offset:2176 nt lds
    s_waitcnt vmcnt(5)
    buffer_load_dwordx4 v15, s[36:39], s55 offen offset:3264 nt lds
    s_add_u32 m0, s57, 8704
    s_waitcnt vmcnt(5)
    buffer_load_dwordx4 v8, s[32:35], s45 offen offset:0 nt lds
    s_waitcnt vmcnt(5)
    buffer_load_dwordx4 v9, s[32:35], s45 offen offset:1088 nt lds
    s_waitcnt vmcnt(5)
    buffer_load_dwordx4 v10, s[32:35], s45 offen offset:2176 nt lds
    s_waitcnt vmcnt(5)
    buffer_load_dwordx4 v11, s[32:35], s45 offen offset:3264 nt lds
    s_add_u32 m0, s57, 26112
    s_waitcnt vmcnt(5)
    buffer_load_dwordx4 v12, s[36:39], s56 offen offset:0 nt lds
    s_waitcnt vmcnt(5)
    s_sub_u32 s98, s98, 1
    s_cbranch_scc1 L_wskip6
    s_barrier
L_wskip6:
    buffer_load_dwordx4 v13, s[36:39], s56 offen offset:1088 nt lds
    s_waitcnt vmcnt(5)
    buffer_load_dwordx4 v14, s[36:39], s56 offen offset:2176 nt lds
    s_waitcnt vmcnt(5)
    buffer_load_dwordx4 v15, s[36:39], s56 offen offset:3264 nt lds
    s_add_u32 s57, s57, 34816
    s_cmp_ge_u32 s57, 104448
    s_cselect_b32 s57, s77, s57
    s_add_u32 s62, s62, 1
L_w5:
    s_cmp_ge_i32 s62, s78
    s_cbranch_scc1 L_wfull
    s_add_u32 s72, s72, s79
    s_cbranch_scc1 L_wh5
    s_mov_b32 s55, s44
    s_mov_b32 s56, s45
    v_readlane_b32 s44, v4, s54
    v_readlane_b32 s45, v5, s54
    s_add_u32 s54, s54, 1
    s_nop 0
    s_add_u32 m0, s57, 0
    s_waitcnt vmcnt(4)
    buffer_load_dwordx4 v8, s[32:35], s44 offen offset:0 nt lds
    s_waitcnt vmcnt(4)
    buffer_load_dwordx4 v9, s[32:35], s44 offen offset:1088 nt lds
    s_waitcnt vmcnt(4)
    buffer_load_dwordx4 v10, s[32:35], s44 offen offset:2176 nt lds
    s_waitcnt vmcnt(4)
    buffer_load_dwordx4 v11, s[32:35], s44 offen offset:3264 nt lds
    s_add_u32 m0, s57, 17408
    s_waitcnt vmcnt(4)
    s_sub_u32 s98, s98, 1
    s_cbranch_scc1 L_wskip7
    s_barrier
L_wskip7:
    buffer_load_dwordx4 v12, s[36:39], s55 offen offset:0 nt lds
    s_waitcnt vmcnt(4)
    buffer_load_dwordx4 v13, s[36:39], s55 offen offset:1088 nt lds
    s_waitcnt vmcnt(4)
    buffer_load_dwordx4 v14, s[36:39], s55 offen offset:2176 nt lds
    s_waitcnt vmcnt(4)
    buffer_load_dwordx4 v15, s[36:39], s55 offen offset:3264 nt lds
    s_add_u32 m0, s57, 8704
    s_waitcnt vmcnt(4)
    buffer_load_dwordx4 v8, s[32:35], s45 offen offset:0 nt lds
    s_waitcnt vmcnt(4)
    buffer_load_dwordx4 v9, s[32:35], s45 offen offset:1088 nt lds
    s_waitcnt vmcnt(4)
    buffer_load_dwordx4 v10, s[32:35], s45 offen offset:2176 nt lds
    s_waitcnt vmcnt(4)
    buffer_load_dwordx4 v11, s[32:35], s45 offen offset:3264 nt lds
    s_add_u32 m0, s57, 26112
    s_waitcnt vmcnt(4)
    s_sub_u32 s98, s98, 1
    s_cbranch_scc1 L_wskip8
    s_barrier
L_wskip8:
    buffer_load_dwordx4 v12, s[36:39], s56 offen offset:0 nt lds
    s_waitcnt vmcnt(4)
    buffer_load_dwordx4 v13, s[36:39], s56 offen offset:1088 nt lds
    s_waitcnt vmcnt(4)
    buffer_load_dwordx4 v14, s[36:39], s56 offen offset:2176 nt lds
    s_waitcnt vmcnt(4)
    buffer_load_dwordx4 v15, s[36:39], s56 offen offset:3264 nt lds
    s_add_u32 s57, s57, 34816
    s_cmp_ge_u32 s57, 104448
    s_cselect_b32 s57, s77, s57
    s_add_u32 s62, s62, 1
    s_branch L_w5
L_wh6:
    s_mov_b32 s55, s44
    s_mov_b32 s56, s45
    v_readlane_b32 s44, v4, s54
    v_readlane_b32 s45, v5, s54
    s_add_u32 s54, s54, 1
    s_nop 0
    s_add_u32 m0, s57, 0
    s_waitcnt vmcnt(6)
    buffer_load_dwordx4 v8, s[32:35], s44 offen offset:0 nt lds
    s_waitcnt vmcnt(6)
    buffer_load_dwordx4 v9, s[32:35], s44 offen offset:1088 nt lds
    s_waitcnt vmcnt(6)
    buffer_load_dwordx4 v10, s[32:35], s44 offen offset:2176 nt lds
    s_waitcnt vmcnt(6)
    buffer_load_dwordx4 v11, s[32:35], s44 offen offset:3264 nt lds
    s_add_u32 m0, s57, 17408
    s_waitcnt vmcnt(6)
    buffer_load_dwordx4 v12, s[36:39], s55 offen offset:0 nt lds
    s_waitcnt vmcnt(6)
    buffer_load_dwordx4 v13, s[36:39], s55 offen offset:1088 nt lds
    s_waitcnt vmcnt(6)
    s_sub_u32 s98, s98, 1
    s_cbranch_scc1 L_wskip9
    s_barrier
L_wskip9:
    buffer_load_dwordx4 v14, s[36:39], s55 offen offset:2176 nt lds
    s_waitcnt vmcnt(6)
    buffer_load_dwordx4 v15, s[36:39], s55 offen offset:3264 nt lds
    s_add_u32 m0, s57, 8704
    s_waitcnt vmcnt(6)
    buffer_load_dwordx4 v8, s[32:35], s45 offen offset:0 nt lds
    s_waitcnt vmcnt(6)
    buffer_load_dwordx4 v9, s[32:35], s45 offen offset:1088 nt lds
    s_waitcnt vmcnt(6)
    buffer_load_dwordx4 v10, s[32:35], s45 offen offset:2176 nt lds
    s_waitcnt vmcnt(6)
    buffer_load_dwordx4 v11, s[32:35], s45 offen offset:3264 nt lds
    s_add_u32 m0, s57, 26112
    s_waitcnt vmcnt(6)
    buffer_load_dwordx4 v12, s[36:39], s56 offen offset:0 nt lds
    s_waitcnt vmcnt(6)
    buffer_load_dwordx4 v13, s[36:39], s56 offen offset:1088 nt lds
    s_waitcnt vmcnt(6)
    s_sub_u32 s98, s98, 1
    s_cbranch_scc1 L_wskip10
    s_barrier
L_wskip10:
    buffer_load_dwordx4 v14, s[36:39], s56 offen offset:2176 nt lds
    s_waitcnt vmcnt(6)
    buffer_load_dwordx4 v15, s[36:39], s56 offen offset:3264 nt lds
    s_add_u32 s57, s57, 34816
    s_cmp_ge_u32 s57, 104448
    s_cselect_b32 s57, s77, s57
    s_add_u32 s62, s62, 1
L_w6:
    s_cmp_ge_i32 s62, s78
    s_cbranch_scc1 L_wfull
    s_add_u32 s72, s72, s79
    s_cbranch_scc1 L_wh6
    s_mov_b32 s55, s44
    s_mov_b32 s56, s45
    v_readlane_b32 s44, v4, s54
    v_readlane_b32 s45, v5, s54
    s_add_u32 s54, s54, 1
    s_nop 0
    s_add_u32 m0, s57, 0
    s_waitcnt vmcnt(5)
    buffer_load_dwordx4 v8, s[32:35], s44 offen offset:0 nt lds
    s_waitcnt vmcnt(5)
    buffer_load_dwordx4 v9, s[32:35], s44 offen offset:1088 nt lds
    s_waitcnt vmcnt(5)
    buffer_load_dwordx4 v10, s[32:35], s44 offen offset:2176 nt lds
    s_waitcnt vmcnt(5)
    buffer_load_dwordx4 v11, s[32:35], s44 offen offset:3264 nt lds
    s_add_u32 m0, s57, 17408
    s_waitcnt vmcnt(5)
    buffer_load_dwordx4 v12, s[36:39], s55 offen offset:0 nt lds
    s_waitcnt vmcnt(5)
    s_sub_u32 s98, s98, 1
    s_cbranch_scc1 L_wskip11
    s_barrier
L_wskip11:
    buffer_load_dwordx4 v13, s[36:39], s55 offen offset:1088 nt lds
    s_waitcnt vmcnt(5)
    buffer_load_dwordx4 v14, s[36:39], s55 offen offset:2176 nt lds
    s_waitcnt vmcnt(5)
    buffer_load_dwordx4 v15, s[36:39], s55 offen offset:3264 nt lds
    s_add_u32 m0, s57, 8704
    s_waitcnt vmcnt(5)
    buffer_load_dwordx4 v8, s[32:35], s45 offen offset:0 nt lds
    s_waitcnt vmcnt(5)
    buffer_load_dwordx4 v9, s[32:35], s45 offen offset:1088 nt lds
    s_waitcnt vmcnt(5)
    buffer_load_dwordx4 v10, s[32:35], s45 offen offset:2176 nt lds
    s_waitcnt vmcnt(5)
    buffer_load_dwordx4 v11, s[32:35], s45 offen offset:3264 nt lds
    s_add_u32 m0, s57, 26112
    s_waitcnt vmcnt(5)
    buffer_load_dwordx4 v12, s[36:39], s56 offen offset:0 nt lds
    s_waitcnt vmcnt(5)
    s_sub_u32 s98, s98, 1
    s_cbranch_scc1 L_wskip12
    s_barrier
L_wskip12:
    buffer_load_dwordx4 v13, s[36:39], s56 offen offset:1088 nt lds
    s_waitcnt vmcnt(5)
    buffer_load_dwordx4 v14, s[36:39], s56 offen offset:2176 nt lds
    s_waitcnt vmcnt(5)
    buffer_load_dwordx4 v15, s[36:39], s56 offen offset:3264 nt lds
    s_add_u32 s57, s57, 34816
    s_cmp_ge_u32 s57, 104448
    s_cselect_b32 s57, s77, s57
    s_add_u32 s62, s62, 1
    s_branch L_w6
L_wh7:
    s_mov_b32 s55, s44
    s_mov_b32 s56, s45
    v_readlane_b32 s44, v4, s54
    v_readlane_b32 s45, v5, s54
    s_add_u32 s54, s54, 1
    s_nop 0
    s_add_u32 m0, s57, 0
    s_waitcnt vmcnt(7)
    buffer_load_dwordx4 v8, s[32:35], s44 offen offset:0 nt lds
    s_waitcnt vmcnt(7)
    buffer_load_dwordx4 v9, s[32:35], s44 offen offset:1088 nt lds
    s_waitcnt vmcnt(7)
    buffer_load_dwordx4 v10, s[32:35], s44 offen offset:2176 nt lds
    s_waitcnt vmcnt(7)
    buffer_load_dwordx4 v11, s[32:35], s44 offen offset:3264 nt lds
    s_add_u32 m0, s57, 17408
    s_waitcnt vmcnt(7)
    buffer_load_dwordx4 v12, s[36:39], s55 offen offset:0 nt lds
    s_waitcnt vmcnt(7)
    buffer_load_dwordx4 v13, s[36:39], s55 offen offset:1088 nt lds
    s_waitcnt vmcnt(7)
    buffer_load_dwordx4 v14, s[36:39], s55 offen offset:2176 nt lds
    s_waitcnt vmcnt(7)
    s_sub_u32 s98, s98, 1
    s_cbranch_scc1 L_wskip13
    s_barrier
L_wskip13:
    buffer_load_dwordx4 v15, s[36:39], s55 offen offset:3264 nt lds
    s_add_u32 m0, s57, 8704
    s_waitcnt vmcnt(7)
    buffer_load_dwordx4 v8, s[32:35], s45 offen offset:0 nt lds
    s_waitcnt vmcnt(7)
    buffer_load_dwordx4 v9, s[32:35], s45 offen offset:1088 nt lds
    s_waitcnt vmcnt(7)
    buffer_load_dwordx4 v10, s[32:35], s45 offen offset:2176 nt lds
    s_waitcnt vmcnt(7)
    buffer_load_dwordx4 v11, s[32:35], s45 offen offset:3264 nt lds
    s_add_u32 m0, s57, 26112
    s_waitcnt vmcnt(7)
    buffer_load_dwordx4 v12, s[36:39], s56 offen offset:0 nt lds
    s_waitcnt vmcnt(7)
    buffer_load_dwordx4 v13, s[36:39], s56 offen offset:1088 nt lds
    s_waitcnt vmcnt(7)
    buffer_load_dwordx4 v14, s[36:39], s56 offen offset:2176 nt lds
    s_waitcnt vmcnt(7)
    s_sub_u32 s98, s98, 1
    s_cbranch_scc1 L_wskip14
    s_barrier
L_wskip14:
    buffer_load_dwordx4 v15, s[36:39], s56 offen offset:3264 nt lds
    s_add_u32 s57, s57, 34816
    s_cmp_ge_u32 s57, 104448
    s_cselect_b32 s57, s77, s57
    s_add_u32 s62, s62, 1
L_w7:
    s_cmp_ge_i32 s62, s78
    s_cbranch_scc1 L_wfull
    s_add_u32 s72, s72, s79
    s_cbranch_scc1 L_wh7
    s_mov_b32 s55, s44
    s_mov_b32 s56, s45
    v_readlane_b32 s44, v4, s54
    v_readlane_b32 s45, v5, s54
    s_add_u32 s54, s54, 1
    s_nop 0
    s_add_u32 m0, s57, 0
    s_waitcnt vmcnt(6)
    buffer_load_dwordx4 v8, s[32:35], s44 offen offset:0 nt lds
    s_waitcnt vmcnt(6)
    buffer_load_dwordx4 v9, s[32:35], s44 offen offset:1088 nt lds
    s_waitcnt vmcnt(6)
    buffer_load_dwordx4 v10, s[32:35], s44 offen offset:2176 nt lds
    s_waitcnt vmcnt(6)
    buffer_load_dwordx4 v11, s[32:35], s44 offen offset:3264 nt lds
    s_add_u32 m0, s57, 17408
    s_waitcnt vmcnt(6)
    buffer_load_dwordx4 v12, s[36:39], s55 offen offset:0 nt lds
    s_waitcnt vmcnt(6)
    buffer_load_dwordx4 v13, s[36:39], s55 offen offset:1088 nt lds
    s_waitcnt vmcnt(6)
    s_sub_u32 s98, s98, 1
    s_cbranch_scc1 L_wskip15
    s_barrier
L_wskip15:
    buffer_load_dwordx4 v14, s[36:39], s55 offen offset:2176 nt lds
    s_waitcnt vmcnt(6)
    buffer_load_dwordx4 v15, s[36:39], s55 offen offset:3264 nt lds
    s_add_u32 m0, s57, 8704
    s_waitcnt vmcnt(6)
    buffer_load_dwordx4 v8, s[32:35], s45 offen offset:0 nt lds
    s_waitcnt vmcnt(6)
    buffer_load_dwordx4 v9, s[32:35], s45 offen offset:1088 nt lds
    s_waitcnt vmcnt(6)
    buffer_load_dwordx4 v10, s[32:35], s45 offen offset:2176 nt lds
    s_waitcnt vmcnt(6)
    buffer_load_dwordx4 v11, s[32:35], s45 offen offset:3264 nt lds
    s_add_u32 m0, s57, 26112
    s_waitcnt vmcnt(6)
    buffer_load_dwordx4 v12, s[36:39], s56 offen offset:0 nt lds
    s_waitcnt vmcnt(6)
    buffer_load_dwordx4 v13, s[36:39], s56 offen offset:1088 nt lds
    s_waitcnt vmcnt(6)
    s_sub_u32 s98, s98, 1
    s_cbranch_scc1 L_wskip16
    s_barrier
L_wskip16:
    buffer_load_dwordx4 v14, s[36:39], s56 offen offset:2176 nt lds
    s_waitcnt vmcnt(6)
    buffer_load_dwordx4 v15, s[36:39], s56 offen offset:3264 nt lds
    s_add_u32 s57, s57, 34816
    s_cmp_ge_u32 s57, 104448
    s_cselect_b32 s57, s77, s57
    s_add_u32 s62, s62, 1
    s_branch L_w7
L_wh8:
    s_mov_b32 s55, s44
    s_mov_b32 s56, s45
    v_readlane_b32 s44, v4, s54
    v_readlane_b32 s45, v5, s54
    s_add_u32 s54, s54, 1
    s_nop 0
    s_add_u32 m0, s57, 0
    s_waitcnt vmcnt(8)
    buffer_load_dwordx4 v8, s[32:35], s44 offen offset:0 nt lds
    s_waitcnt vmcnt(8)
    buffer_load_dwordx4 v9, s[32:35], s44 offen offset:1088 nt lds
    s_waitcnt vmcnt(8)
    buffer_load_dwordx4 v10, s[32:35], s44 offen offset:2176 nt lds
    s_waitcnt vmcnt(8)
    buffer_load_dwordx4 v11, s[32:35], s44 offen offset:3264 nt lds
    s_add_u32 m0, s57, 17408
    s_waitcnt vmcnt(8)
    buffer_load_dwordx4 v12, s[36:39], s55 offen offset:0 nt lds
    s_waitcnt vmcnt(8)
    buffer_load_dwordx4 v13, s[36:39], s55 offen offset:1088 nt lds
    s_waitcnt vmcnt(8)
    buffer_load_dwordx4 v14, s[36:39], s55 offen offset:2176 nt lds
    s_waitcnt vmcnt(8)
    buffer_load_dwordx4 v15, s[36:39], s55 offen offset:3264 nt lds
    s_add_u32 m0, s57, 8704
    s_waitcnt vmcnt(8)
    s_sub_u32 s98, s98, 1
    s_cbranch_scc1 L_wskip17
    s_barrier
L_wskip17:
    buffer_load_dwordx4 v8, s[32:35], s45 offen offset:0 nt lds
    s_waitcnt vmcnt(8)
    buffer_load_dwordx4 v9, s[32:35], s45 offen offset:1088 nt lds
    s_waitcnt vmcnt(8)
    buffer_load_dwordx4 v10, s[32:35], s45 offen offset:2176 nt lds
    s_waitcnt vmcnt(8)
    buffer_load_dwordx4 v11, s[32:35], s45 offen offset:3264 nt lds
    s_add_u32 m0, s57, 26112
    s_waitcnt vmcnt(8)
    buffer_load_dwordx4 v12, s[36:39], s56 offen offset:0 nt lds
    s_waitcnt vmcnt(8)
    buffer_load_dwordx4 v13, s[36:39], s56 offen offset:1088 nt lds
    s_waitcnt vmcnt(8)
    buffer_load_dwordx4 v14, s[36:39], s56 offen offset:2176 nt lds
    s_waitcnt vmcnt(8)
    buffer_load_dwordx4 v15, s[36:39], s56 offen offset:3264 nt lds
    s_waitcnt vmcnt(8)
    s_sub_u32 s98, s98, 1
    s_cbranch_scc1 L_wskip18
    s_barrier
L_wskip18:
    s_add_u32 s57, s57, 34816
    s_cmp_ge_u32 s57, 104448
    s_cselect_b32 s57, s77, s57
    s_add_u32 s62, s62, 1
L_w8:
    s_cmp_ge_i32 s62, s78
    s_cbranch_scc1 L_wfull
    s_add_u32 s72, s72, s79
    s_cbranch_scc1 L_wh8
    s_mov_b32 s55, s44
    s_mov_b32 s56, s45
    v_readlane_b32 s44, v4, s54
    v_readlane_b32 s45, v5, s54
    s_add_u32 s54, s54, 1
    s_nop 0
    s_add_u32 m0, s57, 0
    s_waitcnt vmcnt(7)
    buffer_load_dwordx4 v8, s[32:35], s44 offen offset:0 nt lds
    s_waitcnt vmcnt(7)
    buffer_load_dwordx4 v9, s[32:35], s44 offen offset:1088 nt lds
    s_waitcnt vmcnt(7)
    buffer_load_dwordx4 v10, s[32:35], s44 offen offset:2176 nt lds
    s_waitcnt vmcnt(7)
    buffer_load_dwordx4 v11, s[32:35], s44 offen offset:3264 nt lds
    s_add_u32 m0, s57, 17408
    s_waitcnt vmcnt(7)
    buffer_load_dwordx4 v12, s[36:39], s55 offen offset:0 nt lds
    s_waitcnt vmcnt(7)
    buffer_load_dwordx4 v13, s[36:39], s55 offen offset:1088 nt lds
    s_waitcnt vmcnt(7)
    buffer_load_dwordx4 v14, s[36:39], s55 offen offset:2176 nt lds
    s_waitcnt vmcnt(7)
    s_sub_u32 s98, s98, 1
    s_cbranch_scc1 L_wskip19
    s_barrier
L_wskip19:
    buffer_load_dwordx4 v15, s[36:39], s55 offen offset:3264 nt lds
    s_add_u32 m0, s57, 8704
    s_waitcnt vmcnt(7)
    buffer_load_dwordx4 v8, s[32:35], s45 offen offset:0 nt lds
    s_waitcnt vmcnt(7)
    buffer_load_dwordx4 v9, s[32:35], s45 offen offset:1088 nt lds
    s_waitcnt vmcnt(7)
    buffer_load_dwordx4 v10, s[32:35], s45 offen offset:2176 nt lds
    s_waitcnt vmcnt(7)
    buffer_load_dwordx4 v11, s[32:35], s45 offen offset:3264 nt lds
    s_add_u32 m0, s57, 26112
    s_waitcnt vmcnt(7)
    buffer_load_dwordx4 v12, s[36:39], s56 offen offset:0 nt lds
    s_waitcnt vmcnt(7)
    buffer_load_dwordx4 v13, s[36:39], s56 offen offset:1088 nt lds
    s_waitcnt vmcnt(7)
    buffer_load_dwordx4 v14, s[36:39], s56 offen offset:2176 nt lds
    s_waitcnt vmcnt(7)
    s_sub_u32 s98, s98, 1
    s_cbranch_scc1 L_wskip20
    s_barrier
L_wskip20:
    buffer_load_dwordx4 v15, s[36:39], s56 offen offset:3264 nt lds
    s_add_u32 s57, s57, 34816
    s_cmp_ge_u32 s57, 104448
    s_cselect_b32 s57, s77, s57
    s_add_u32 s62, s62, 1
    s_branch L_w8
L_wh9:
    s_mov_b32 s55, s44
    s_mov_b32 s56, s45
    v_readlane_b32 s44, v4, s54
    v_readlane_b32 s45, v5, s54
    s_add_u32 s54, s54, 1
    s_nop 0
    s_add_u32 m0, s57, 0
    s_waitcnt vmcnt(9)
    buffer_load_dwordx4 v8, s[32:35], s44 offen offset:0 nt lds
    s_waitcnt vmcnt(9)
    s_sub_u32 s98, s98, 1
    s_cbranch_scc1 L_wskip21
    s_barrier
L_wskip21:
    buffer_load_dwordx4 v9, s[32:35], s44 offen offset:1088 nt lds
    s_waitcnt vmcnt(9)
    buffer_load_dwordx4 v10, s[32:35], s44 offen offset:2176 nt lds
    s_waitcnt vmcnt(9)
    buffer_load_dwordx4 v11, s[32:35], s44 offen offset:3264 nt lds
    s_add_u32 m0, s57, 17408
    s_waitcnt vmcnt(9)
    buffer_load_dwordx4 v12, s[36:39], s55 offen offset:0 nt lds
    s_waitcnt vmcnt(9)
    buffer_load_dwordx4 v13, s[36:39], s55 offen offset:1088 nt lds
    s_waitcnt vmcnt(9)
    buffer_load_dwordx4 v14, s[36:39], s55 offen offset:2176 nt lds
    s_waitcnt vmcnt(9)
    buffer_load_dwordx4 v15, s[36:39], s55 offen offset:3264 nt lds
    s_add_u32 m0, s57, 8704
    s_waitcnt vmcnt(9)
    buffer_load_dwordx4 v8, s[32:35], s45 offen offset:0 nt lds
    s_waitcnt vmcnt(9)
    s_sub_u32 s98, s98, 1
    s_cbranch_scc1 L_wskip22
    s_barrier
L_wskip22:
    buffer_load_dwordx4 v9, s[32:35], s45 offen offset:1088 nt lds
    s_waitcnt vmcnt(9)
    buffer_load_dwordx4 v10, s[32:35], s45 offen offset:2176 nt lds
    s_waitcnt vmcnt(9)
    buffer_load_dwordx4 v11, s[32:35], s45 offen offset:3264 nt lds
    s_add_u32 m0, s57, 26112
    s_waitcnt vmcnt(9)
    buffer_load_dwordx4 v12, s[36:39], s56 offen offset:0 nt lds
    s_waitcnt vmcnt(9)
    buffer_load_dwordx4 v13, s[36:39], s56 offen offset:1088 nt lds
    s_waitcnt vmcnt(9)
    buffer_load_dwordx4 v14, s[36:39], s56 offen offset:2176 nt lds
    s_waitcnt vmcnt(9)
    buffer_load_dwordx4 v15, s[36:39], s56 offen offset:3264 nt lds
    s_add_u32 s57, s57, 34816
    s_cmp_ge_u32 s57, 104448
    s_cselect_b32 s57, s77, s57
    s_add_u32 s62, s62, 1
L_w9:
    s_cmp_ge_i32 s62, s78
    s_cbranch_scc1 L_wfull
    s_add_u32 s72, s72, s79
    s_cbranch_scc1 L_wh9
    s_mov_b32 s55, s44
    s_mov_b32 s56, s45
    v_readlane_b32 s44, v4, s54
    v_readlane_b32 s45, v5, s54
    s_add_u32 s54, s54, 1
    s_nop 0
    s_add_u32 m0, s57, 0
    s_waitcnt vmcnt(8)
    s_sub_u32 s98, s98, 1
    s_cbranch_scc1 L_wskip23
    s_barrier
L_wskip23:
    buffer_load_dwordx4 v8, s[32:35], s44 offen offset:0 nt lds
    s_waitcnt vmcnt(8)
    buffer_load_dwordx4 v9, s[32:35], s44 offen offset:1088 nt lds
    s_waitcnt vmcnt(8)
    buffer_load_dwordx4 v10, s[32:35], s44 offen offset:2176 nt lds
    s_waitcnt vmcnt(8)
    buffer_load_dwordx4 v11, s[32:35], s44 offen offset:3264 nt lds
    s_add_u32 m0, s57, 17408
    s_waitcnt vmcnt(8)
    buffer_load_dwordx4 v12, s[36:39], s55 offen offset:0 nt lds
    s_waitcnt vmcnt(8)
    buffer_load_dwordx4 v13, s[36:39], s55 offen offset:1088 nt lds
    s_waitcnt vmcnt(8)
    buffer_load_dwordx4 v14, s[36:39], s55 offen offset:2176 nt lds
    s_waitcnt vmcnt(8)
    buffer_load_dwordx4 v15, s[36:39], s55 offen offset:3264 nt lds
    s_add_u32 m0, s57, 8704
    s_waitcnt vmcnt(8)
    s_sub_u32 s98, s98, 1
    s_cbranch_scc1 L_wskip24
    s_barrier
L_wskip24:
    buffer_load_dwordx4 v8, s[32:35], s45 offen offset:0 nt lds
    s_waitcnt vmcnt(8)
    buffer_load_dwordx4 v9, s[32:35], s45 offen offset:1088 nt lds
    s_waitcnt vmcnt(8)
    buffer_load_dwordx4 v10, s[32:35], s45 offen offset:2176 nt lds
    s_waitcnt vmcnt(8)
    buffer_load_dwordx4 v11, s[32:35], s45 offen offset:3264 nt lds
    s_add_u32 m0, s57, 26112
    s_waitcnt vmcnt(8)
    buffer_load_dwordx4 v12, s[36:39], s56 offen offset:0 nt lds
    s_waitcnt vmcnt(8)
    buffer_load_dwordx4 v13, s[36:39], s56 offen offset:1088 nt lds
    s_waitcnt vmcnt(8)
    buffer_load_dwordx4 v14, s[36:39], s56 offen offset:2176 nt lds
    s_waitcnt vmcnt(8)
    buffer_load_dwordx4 v15, s[36:39], s56 offen offset:3264 nt lds
    s_add_u32 s57, s57, 34816
    s_cmp_ge_u32 s57, 104448
    s_cselect_b32 s57, s77, s57
    s_add_u32 s62, s62, 1
    s_branch L_w9
L_wh10:
    s_mov_b32 s55, s44
    s_mov_b32 s56, s45
    v_readlane_b32 s44, v4, s54
    v_readlane_b32 s45, v5, s54
    s_add_u32 s54, s54, 1
    s_nop 0
    s_add_u32 m0, s57, 0
    s_waitcnt vmcnt(10)
    buffer_load_dwordx4 v8, s[32:35], s44 offen offset:0 nt lds
    s_waitcnt vmcnt(10)
    buffer_load_dwordx4 v9, s[32:35], s44 offen offset:1088 nt lds
    s_waitcnt vmcnt(10)
    s_sub_u32 s98, s98, 1
    s_cbranch_scc1 L_wskip25
    s_barrier
L_wskip25:
    buffer_load_dwordx4 v10, s[32:35], s44 offen offset:2176 nt lds
    s_waitcnt vmcnt(10)
    buffer_load_dwordx4 v11, s[32:35], s44 offen offset:3264 nt lds
    s_add_u32 m0, s57, 17408
    s_waitcnt vmcnt(10)
    buffer_load_dwordx4 v12, s[36:39], s55 offen offset:0 nt lds
    s_waitcnt vmcnt(10)
    buffer_load_dwordx4 v13, s[36:39], s55 offen offset:1088 nt lds
    s_waitcnt vmcnt(10)
    buffer_load_dwordx4 v14, s[36:39], s55 offen offset:2176 nt lds
    s_waitcnt vmcnt(10)
    buffer_load_dwordx4 v15, s[36:39], s55 offen offset:3264 nt lds
    s_add_u32 m0, s57, 8704
    s_waitcnt vmcnt(10)
    buffer_load_dwordx4 v8, s[32:35], s45 offen offset:0 nt lds
    s_waitcnt vmcnt(10)
    buffer_load_dwordx4 v9, s[32:35], s45 offen offset:1088 nt lds
    s_waitcnt vmcnt(10)
    s_sub_u32 s98, s98, 1
    s_cbranch_scc1 L_wskip26
    s_barrier
L_wskip26:
    buffer_load_dwordx4 v10, s[32:35], s45 offen offset:2176 nt lds
    s_waitcnt vmcnt(10)
    buffer_load_dwordx4 v11, s[32:35], s45 offen offset:3264 nt lds
    s_add_u32 m0, s57, 26112
    s_waitcnt vmcnt(10)
    buffer_load_dwordx4 v12, s[36:39], s56 offen offset:0 nt lds
    s_waitcnt vmcnt(10)
    buffer_load_dwordx4 v13, s[36:39], s56 offen offset:1088 nt lds
    s_waitcnt vmcnt(10)
    buffer_load_dwordx4 v14, s[36:39], s56 offen offset:2176 nt lds
    s_waitcnt vmcnt(10)
    buffer_load_dwordx4 v15, s[36:39], s56 offen offset:3264 nt lds
    s_add_u32 s57, s57, 34816
    s_cmp_ge_u32 s57, 104448
    s_cselect_b32 s57, s77, s57
    s_add_u32 s62, s62, 1
L_w10:
    s_cmp_ge_i32 s62, s78
    s_cbranch_scc1 L_wfull
    s_add_u32 s72, s72, s79
    s_cbranch_scc1 L_wh10
    s_mov_b32 s55, s44
    s_mov_b32 s56, s45
    v_readlane_b32 s44, v4, s54
    v_readlane_b32 s45, v5, s54
    s_add_u32 s54, s54, 1
    s_nop 0
    s_add_u32 m0, s57, 0
    s_waitcnt vmcnt(9)
    buffer_load_dwordx4 v8, s[32:35], s44 offen offset:0 nt lds
    s_waitcnt vmcnt(9)
    s_sub_u32 s98, s98, 1
    s_cbranch_scc1 L_wskip27
    s_barrier
L_wskip27:
    buffer_load_dwordx4 v9, s[32:35], s44 offen offset:1088 nt lds
    s_waitcnt vmcnt(9)
    buffer_load_dwordx4 v10, s[32:35], s44 offen offset:2176 nt lds
    s_waitcnt vmcnt(9)
    buffer_load_dwordx4 v11, s[32:35], s44 offen offset:3264 nt lds
    s_add_u32 m0, s57, 17408
    s_waitcnt vmcnt(9)
    buffer_load_dwordx4 v12, s[36:39], s55 offen offset:0 nt lds
    s_waitcnt vmcnt(9)
    buffer_load_dwordx4 v13, s[36:39], s55 offen offset:1088 nt lds
    s_waitcnt vmcnt(9)
    buffer_load_dwordx4 v14, s[36:39], s55 offen offset:2176 nt lds
    s_waitcnt vmcnt(9)
    buffer_load_dwordx4 v15, s[36:39], s55 offen offset:3264 nt lds
    s_add_u32 m0, s57, 8704
    s_waitcnt vmcnt(9)
    buffer_load_dwordx4 v8, s[32:35], s45 offen offset:0 nt lds
    s_waitcnt vmcnt(9)
    s_sub_u32 s98, s98, 1
    s_cbranch_scc1 L_wskip28
    s_barrier
L_wskip28:
    buffer_load_dwordx4 v9, s[32:35], s45 offen offset:1088 nt lds
    s_waitcnt vmcnt(9)
    buffer_load_dwordx4 v10, s[32:35], s45 offen offset:2176 nt lds
    s_waitcnt vmcnt(9)
    buffer_load_dwordx4 v11, s[32:35], s45 offen offset:3264 nt lds
    s_add_u32 m0, s57, 26112
    s_waitcnt vmcnt(9)
    buffer_load_dwordx4 v12, s[36:39], s56 offen offset:0 nt lds
    s_waitcnt vmcnt(9)
    buffer_load_dwordx4 v13, s[36:39], s56 offen offset:1088 nt lds
    s_waitcnt vmcnt(9)
    buffer_load_dwordx4 v14, s[36:39], s56 offen offset:2176 nt lds
    s_waitcnt vmcnt(9)
    buffer_load_dwordx4 v15, s[36:39], s56 offen offset:3264 nt lds
    s_add_u32 s57, s57, 34816
    s_cmp_ge_u32 s57, 104448
    s_cselect_b32 s57, s77, s57
    s_add_u32 s62, s62, 1
    s_branch L_w10
L_wh11:
    s_mov_b32 s55, s44
    s_mov_b32 s56, s45
    v_readlane_b32 s44, v4, s54
    v_readlane_b32 s45, v5, s54
    s_add_u32 s54, s54, 1
    s_nop 0
    s_add_u32 m0, s57, 0
    s_waitcnt vmcnt(11)
    buffer_load_dwordx4 v8, s[32:35], s44 offen offset:0 nt lds
    s_waitcnt vmcnt(11)
    buffer_load_dwordx4 v9, s[32:35], s44 offen offset:1088 nt lds
    s_waitcnt vmcnt(11)
    buffer_load_dwordx4 v10, s[32:35], s44 offen offset:2176 nt lds
    s_waitcnt vmcnt(11)
    s_sub_u32 s98, s98, 1
    s_cbranch_scc1 L_wskip29
    s_barrier
L_wskip29:
    buffer_load_dwordx4 v11, s[32:35], s44 offen offset:3264 nt lds
    s_add_u32 m0, s57, 17408
    s_waitcnt vmcnt(11)
    buffer_load_dwordx4 v12, s[36:39], s55 offen offset:0 nt lds
    s_waitcnt vmcnt(11)
    buffer_load_dwordx4 v13, s[36:39], s55 offen offset:1088 nt lds
    s_waitcnt vmcnt(11)
    buffer_load_dwordx4 v14, s[36:39], s55 offen offset:2176 nt lds
    s_waitcnt vmcnt(11)
    buffer_load_dwordx4 v15, s[36:39], s55 offen offset:3264 nt lds
    s_add_u32 m0, s57, 8704
    s_waitcnt vmcnt(11)
    buffer_load_dwordx4 v8, s[32:35], s45 offen offset:0 nt lds
    s_waitcnt vmcnt(11)
    buffer_load_dwordx4 v9, s[32:35], s45 offen offset:1088 nt lds
    s_waitcnt vmcnt(11)
    buffer_load_dwordx4 v10, s[32:35], s45 offen offset:2176 nt lds
    s_waitcnt vmcnt(11)
    s_sub_u32 s98, s98, 1
    s_cbranch_scc1 L_wskip30
    s_barrier
L_wskip30:
    buffer_load_dwordx4 v11, s[32:35], s45 offen offset:3264 nt lds
    s_add_u32 m0, s57, 26112
    s_waitcnt vmcnt(11)
    buffer_load_dwordx4 v12, s[36:39], s56 offen offset:0 nt lds
    s_waitcnt vmcnt(11)
    buffer_load_dwordx4 v13, s[36:39], s56 offen offset:1088 nt lds
    s_waitcnt vmcnt(11)
    buffer_load_dwordx4 v14, s[36:39], s56 offen offset:2176 nt lds
    s_waitcnt vmcnt(11)
    buffer_load_dwordx4 v15, s[36:39], s56 offen offset:3264 nt lds
    s_add_u32 s57, s57, 34816
    s_cmp_ge_u32 s57, 104448
    s_cselect_b32 s57, s77, s57
    s_add_u32 s62, s62, 1
L_w11:
    s_cmp_ge_i32 s62, s78
    s_cbranch_scc1 L_wfull
    s_add_u32 s72, s72, s79
    s_cbranch_scc1 L_wh11
    s_mov_b32 s55, s44
    s_mov_b32 s56, s45
    v_readlane_b32 s44, v4, s54
    v_readlane_b32 s45, v5, s54
    s_add_u32 s54, s54, 1
    s_nop 0
    s_add_u32 m0, s57, 0
    s_waitcnt vmcnt(10)
    buffer_load_dwordx4 v8, s[32:35], s44 offen offset:0 nt lds
    s_waitcnt vmcnt(10)
    buffer_load_dwordx4 v9, s[32:35], s44 offen offset:1088 nt lds
    s_waitcnt vmcnt(10)
    s_sub_u32 s98, s98, 1
    s_cbranch_scc1 L_wskip31
    s_barrier
L_wskip31:
    buffer_load_dwordx4 v10, s[32:35], s44 offen offset:2176 nt lds
    s_waitcnt vmcnt(10)
    buffer_load_dwordx4 v11, s[32:35], s44 offen offset:3264 nt lds
    s_add_u32 m0, s57, 17408
    s_waitcnt vmcnt(10)
    buffer_load_dwordx4 v12, s[36:39], s55 offen offset:0 nt lds
    s_waitcnt vmcnt(10)
    buffer_load_dwordx4 v13, s[36:39], s55 offen offset:1088 nt lds
    s_waitcnt vmcnt(10)
    buffer_load_dwordx4 v14, s[36:39], s55 offen offset:2176 nt lds
    s_waitcnt vmcnt(10)
    buffer_load_dwordx4 v15, s[36:39], s55 offen offset:3264 nt lds
    s_add_u32 m0, s57, 8704
    s_waitcnt vmcnt(10)
    buffer_load_dwordx4 v8, s[32:35], s45 offen offset:0 nt lds
    s_waitcnt vmcnt(10)
    buffer_load_dwordx4 v9, s[32:35], s45 offen offset:1088 nt lds
    s_waitcnt vmcnt(10)
    s_sub_u32 s98, s98, 1
    s_cbranch_scc1 L_wskip32
    s_barrier
L_wskip32:
    buffer_load_dwordx4 v10, s[32:35], s45 offen offset:2176 nt lds
    s_waitcnt vmcnt(10)
    buffer_load_dwordx4 v11, s[32:35], s45 offen offset:3264 nt lds
    s_add_u32 m0, s57, 26112
    s_waitcnt vmcnt(10)
    buffer_load_dwordx4 v12, s[36:39], s56 offen offset:0 nt lds
    s_waitcnt vmcnt(10)
    buffer_load_dwordx4 v13, s[36:39], s56 offen offset:1088 nt lds
    s_waitcnt vmcnt(10)
    buffer_load_dwordx4 v14, s[36:39], s56 offen offset:2176 nt lds
    s_waitcnt vmcnt(10)
    buffer_load_dwordx4 v15, s[36:39], s56 offen offset:3264 nt lds
    s_add_u32 s57, s57, 34816
    s_cmp_ge_u32 s57, 104448
    s_cselect_b32 s57, s77, s57
    s_add_u32 s62, s62, 1
    s_branch L_w11
L_wh12:
    s_mov_b32 s55, s44
    s_mov_b32 s56, s45
    v_readlane_b32 s44, v4, s54
    v_readlane_b32 s45, v5, s54
    s_add_u32 s54, s54, 1
    s_nop 0
    s_add_u32 m0, s57, 0
    s_waitcnt vmcnt(12)
    buffer_load_dwordx4 v8, s[32:35], s44 offen offset:0 nt lds
    s_waitcnt vmcnt(12)
    buffer_load_dwordx4 v9, s[32:35], s44 offen offset:1088 nt lds
    s_waitcnt vmcnt(12)
    buffer_load_dwordx4 v10, s[32:35], s44 offen offset:2176 nt lds
    s_waitcnt vmcnt(12)
    buffer_load_dwordx4 v11, s[32:35], s44 offen offset:3264 nt lds
    s_add_u32 m0, s57, 17408
    s_waitcnt vmcnt(12)
    s_sub_u32 s98, s98, 1
    s_cbranch_scc1 L_wskip33
    s_barrier
L_wskip33:
    buffer_load_dwordx4 v12, s[36:39], s55 offen offset:0 nt lds
    s_waitcnt vmcnt(12)
    buffer_load_dwordx4 v13, s[36:39], s55 offen offset:1088 nt lds
    s_waitcnt vmcnt(12)
    buffer_load_dwordx4 v14, s[36:39], s55 offen offset:2176 nt lds
    s_waitcnt vmcnt(12)
    buffer_load_dwordx4 v15, s[36:39], s55 offen offset:3264 nt lds
    s_add_u32 m0, s57, 8704
    s_waitcnt vmcnt(12)
    buffer_load_dwordx4 v8, s[32:35], s45 offen offset:0 nt lds
    s_waitcnt vmcnt(12)
    buffer_load_dwordx4 v9, s[32:35], s45 offen offset:1088 nt lds
    s_waitcnt vmcnt(12)
    buffer_load_dwordx4 v10, s[32:35], s45 offen offset:2176 nt lds
    s_waitcnt vmcnt(12)
    buffer_load_dwordx4 v11, s[32:35], s45 offen offset:3264 nt lds
    s_add_u32 m0, s57, 26112
    s_waitcnt vmcnt(12)
    s_sub_u32 s98, s98, 1
    s_cbranch_scc1 L_wskip34
    s_barrier
L_wskip34:
    buffer_load_dwordx4 v12, s[36:39], s56 offen offset:0 nt lds
    s_waitcnt vmcnt(12)
    buffer_load_dwordx4 v13, s[36:39], s56 offen offset:1088 nt lds
    s_waitcnt vmcnt(12)
    buffer_load_dwordx4 v14, s[36:39], s56 offen offset:2176 nt lds
    s_waitcnt vmcnt(12)
    buffer_load_dwordx4 v15, s[36:39], s56 offen offset:3264 nt lds
    s_add_u32 s57, s57, 34816
    s_cmp_ge_u32 s57, 104448
    s_cselect_b32 s57, s77, s57
    s_add_u32 s62, s62, 1
L_w12:
    s_cmp_ge_i32 s62, s78
    s_cbranch_scc1 L_wfull
    s_add_u32 s72, s72, s79
    s_cbranch_scc1 L_wh12
    s_mov_b32 s55, s44
    s_mov_b32 s56, s45
    v_readlane_b32 s44, v4, s54
    v_readlane_b32 s45, v5, s54
    s_add_u32 s54, s54, 1
    s_nop 0
    s_add_u32 m0, s57, 0
    s_waitcnt vmcnt(11)
    buffer_load_dwordx4 v8, s[32:35], s44 offen offset:0 nt lds
    s_waitcnt vmcnt(11)
    buffer_load_dwordx4 v9, s[32:35], s44 offen offset:1088 nt lds
    s_waitcnt vmcnt(11)
    buffer_load_dwordx4 v10, s[32:35], s44 offen offset:2176 nt lds
    s_waitcnt vmcnt(11)
    s_sub_u32 s98, s98, 1
    s_cbranch_scc1 L_wskip35
    s_barrier
L_wskip35:
    buffer_load_dwordx4 v11, s[32:35], s44 offen offset:3264 nt lds
    s_add_u32 m0, s57, 17408
    s_waitcnt vmcnt(11)
    buffer_load_dwordx4 v12, s[36:39], s55 offen offset:0 nt lds
    s_waitcnt vmcnt(11)
    buffer_load_dwordx4 v13, s[36:39], s55 offen offset:1088 nt lds
    s_waitcnt vmcnt(11)
    buffer_load_dwordx4 v14, s[36:39], s55 offen offset:2176 nt lds
    s_waitcnt vmcnt(11)
    buffer_load_dwordx4 v15, s[36:39], s55 offen offset:3264 nt lds
    s_add_u32 m0, s57, 8704
    s_waitcnt vmcnt(11)
    buffer_load_dwordx4 v8, s[32:35], s45 offen offset:0 nt lds
    s_waitcnt vmcnt(11)
    buffer_load_dwordx4 v9, s[32:35], s45 offen offset:1088 nt lds
    s_waitcnt vmcnt(11)
    buffer_load_dwordx4 v10, s[32:35], s45 offen offset:2176 nt lds
    s_waitcnt vmcnt(11)
    s_sub_u32 s98, s98, 1
    s_cbranch_scc1 L_wskip36
    s_barrier
L_wskip36:
    buffer_load_dwordx4 v11, s[32:35], s45 offen offset:3264 nt lds
    s_add_u32 m0, s57, 26112
    s_waitcnt vmcnt(11)
    buffer_load_dwordx4 v12, s[36:39], s56 offen offset:0 nt lds
    s_waitcnt vmcnt(11)
    buffer_load_dwordx4 v13, s[36:39], s56 offen offset:1088 nt lds
    s_waitcnt vmcnt(11)
    buffer_load_dwordx4 v14, s[36:39], s56 offen offset:2176 nt lds
    s_waitcnt vmcnt(11)
    buffer_load_dwordx4 v15, s[36:39], s56 offen offset:3264 nt lds
    s_add_u32 s57, s57, 34816
    s_cmp_ge_u32 s57, 104448
    s_cselect_b32 s57, s77, s57
    s_add_u32 s62, s62, 1
    s_branch L_w12
L_wh13:
    s_mov_b32 s55, s44
    s_mov_b32 s56, s45
    v_readlane_b32 s44, v4, s54
    v_readlane_b32 s45, v5, s54
    s_add_u32 s54, s54, 1
    s_nop 0
    s_add_u32 m0, s57, 0
    s_waitcnt vmcnt(13)
    buffer_load_dwordx4 v8, s[32:35], s44 offen offset:0 nt lds
    s_waitcnt vmcnt(13)
    buffer_load_dwordx4 v9, s[32:35], s44 offen offset:1088 nt lds
    s_waitcnt vmcnt(13)
    buffer_load_dwordx4 v10, s[32:35], s44 offen offset:2176 nt lds
    s_waitcnt vmcnt(13)
    buffer_load_dwordx4 v11, s[32:35], s44 offen offset:3264 nt lds
    s_add_u32 m0, s57, 17408
    s_waitcnt vmcnt(13)
    buffer_load_dwordx4 v12, s[36:39], s55 offen offset:0 nt lds
    s_waitcnt vmcnt(13)
    s_sub_u32 s98, s98, 1
    s_cbranch_scc1 L_wskip37
    s_barrier
L_wskip37:
    buffer_load_dwordx4 v13, s[36:39], s55 offen offset:1088 nt lds
    s_waitcnt vmcnt(13)
    buffer_load_dwordx4 v14, s[36:39], s55 offen offset:2176 nt lds
    s_waitcnt vmcnt(13)
    buffer_load_dwordx4 v15, s[36:39], s55 offen offset:3264 nt lds
    s_add_u32 m0, s57, 8704
    s_waitcnt vmcnt(13)
    buffer_load_dwordx4 v8, s[32:35], s45 offen offset:0 nt lds
    s_waitcnt vmcnt(13)
    buffer_load_dwordx4 v9, s[32:35], s45 offen offset:1088 nt lds
    s_waitcnt vmcnt(13)
    buffer_load_dwordx4 v10, s[32:35], s45 offen offset:2176 nt lds
    s_waitcnt vmcnt(13)
    buffer_load_dwordx4 v11, s[32:35], s45 offen offset:3264 nt lds
    s_add_u32 m0, s57, 26112
    s_waitcnt vmcnt(13)
    buffer_load_dwordx4 v12, s[36:39], s56 offen offset:0 nt lds
    s_waitcnt vmcnt(13)
    s_sub_u32 s98, s98, 1
    s_cbranch_scc1 L_wskip38
    s_barrier
L_wskip38:
    buffer_load_dwordx4 v13, s[36:39], s56 offen offset:1088 nt lds
    s_waitcnt vmcnt(13)
    buffer_load_dwordx4 v14, s[36:39], s56 offen offset:2176 nt lds
    s_waitcnt vmcnt(13)
    buffer_load_dwordx4 v15, s[36:39], s56 offen offset:3264 nt lds
    s_add_u32 s57, s57, 34816
    s_cmp_ge_u32 s57, 104448
    s_cselect_b32 s57, s77, s57
    s_add_u32 s62, s62, 1
L_w13:
    s_cmp_ge_i32 s62, s78
    s_cbranch_scc1 L_wfull
    s_add_u32 s72, s72, s79
    s_cbranch_scc1 L_wh13
    s_mov_b32 s55, s44
    s_mov_b32 s56, s45
    v_readlane_b32 s44, v4, s54
    v_readlane_b32 s45, v5, s54
    s_add_u32 s54, s54, 1
    s_nop 0
    s_add_u32 m0, s57, 0
    s_waitcnt vmcnt(12)
    buffer_load_dwordx4 v8, s[32:35], s44 offen offset:0 nt lds
    s_waitcnt vmcnt(12)
    buffer_load_dwordx4 v9, s[32:35], s44 offen offset:1088 nt lds
    s_waitcnt vmcnt(12)
    buffer_load_dwordx4 v10, s[32:35], s44 offen offset:2176 nt lds
    s_waitcnt vmcnt(12)
    buffer_load_dwordx4 v11, s[32:35], s44 offen offset:3264 nt lds
    s_add_u32 m0, s57, 17408
    s_waitcnt vmcnt(12)
    s_sub_u32 s98, s98, 1
    s_cbranch_scc1 L_wskip39
    s_barrier
L_wskip39:
    buffer_load_dwordx4 v12, s[36:39], s55 offen offset:0 nt lds
    s_waitcnt vmcnt(12)
    buffer_load_dwordx4 v13, s[36:39], s55 offen offset:1088 nt lds
    s_waitcnt vmcnt(12)
    buffer_load_dwordx4 v14, s[36:39], s55 offen offset:2176 nt lds
    s_waitcnt vmcnt(12)
    buffer_load_dwordx4 v15, s[36:39], s55 offen offset:3264 nt lds
    s_add_u32 m0, s57, 8704
    s_waitcnt vmcnt(12)
    buffer_load_dwordx4 v8, s[32:35], s45 offen offset:0 nt lds
    s_waitcnt vmcnt(12)
    buffer_load_dwordx4 v9, s[32:35], s45 offen offset:1088 nt lds
    s_waitcnt vmcnt(12)
    buffer_load_dwordx4 v10, s[32:35], s45 offen offset:2176 nt lds
    s_waitcnt vmcnt(12)
    buffer_load_dwordx4 v11, s[32:35], s45 offen offset:3264 nt lds
    s_add_u32 m0, s57, 26112
    s_waitcnt vmcnt(12)
    s_sub_u32 s98, s98, 1
    s_cbranch_scc1 L_wskip40
    s_barrier
L_wskip40:
    buffer_load_dwordx4 v12, s[36:39], s56 offen offset:0 nt lds
    s_waitcnt vmcnt(12)
    buffer_load_dwordx4 v13, s[36:39], s56 offen offset:1088 nt lds
    s_waitcnt vmcnt(12)
    buffer_load_dwordx4 v14, s[36:39], s56 offen offset:2176 nt lds
    s_waitcnt vmcnt(12)
    buffer_load_dwordx4 v15, s[36:39], s56 offen offset:3264 nt lds
    s_add_u32 s57, s57, 34816
    s_cmp_ge_u32 s57, 104448
    s_cselect_b32 s57, s77, s57
    s_add_u32 s62, s62, 1
    s_branch L_w13
L_wh14:
    s_mov_b32 s55, s44
    s_mov_b32 s56, s45
    v_readlane_b32 s44, v4, s54
    v_readlane_b32 s45, v5, s54
    s_add_u32 s54, s54, 1
    s_nop 0
    s_add_u32 m0, s57, 0
    s_waitcnt vmcnt(14)
    buffer_load_dwordx4 v8, s[32:35], s44 offen offset:0 nt lds
    s_waitcnt vmcnt(14)
    buffer_load_dwordx4 v9, s[32:35], s44 offen offset:1088 nt lds
    s_waitcnt vmcnt(14)
    buffer_load_dwordx4 v10, s[32:35], s44 offen offset:2176 nt lds
    s_waitcnt vmcnt(14)
    buffer_load_dwordx4 v11, s[32:35], s44 offen offset:3264 nt lds
    s_add_u32 m0, s57, 17408
    s_waitcnt vmcnt(14)
    buffer_load_dwordx4 v12, s[36:39], s55 offen offset:0 nt lds
    s_waitcnt vmcnt(14)
    buffer_load_dwordx4 v13, s[36:39], s55 offen offset:1088 nt lds
    s_waitcnt vmcnt(14)
    s_sub_u32 s98, s98, 1
    s_cbranch_scc1 L_wskip41
    s_barrier
L_wskip41:
    buffer_load_dwordx4 v14, s[36:39], s55 offen offset:2176 nt lds
    s_waitcnt vmcnt(14)
    buffer_load_dwordx4 v15, s[36:39], s55 offen offset:3264 nt lds
    s_add_u32 m0, s57, 8704
    s_waitcnt vmcnt(14)
    buffer_load_dwordx4 v8, s[32:35], s45 offen offset:0 nt lds
    s_waitcnt vmcnt(14)
    buffer_load_dwordx4 v9, s[32:35], s45 offen offset:1088 nt lds
    s_waitcnt vmcnt(14)
    buffer_load_dwordx4 v10, s[32:35], s45 offen offset:2176 nt lds
    s_waitcnt vmcnt(14)
    buffer_load_dwordx4 v11, s[32:35], s45 offen offset:3264 nt lds
    s_add_u32 m0, s57, 26112
    s_waitcnt vmcnt(14)
    buffer_load_dwordx4 v12, s[36:39], s56 offen offset:0 nt lds
    s_waitcnt vmcnt(14)
    buffer_load_dwordx4 v13, s[36:39], s56 offen offset:1088 nt lds
    s_waitcnt vmcnt(14)
    s_sub_u32 s98, s98, 1
    s_cbranch_scc1 L_wskip42
    s_barrier
L_wskip42:
    buffer_load_dwordx4 v14, s[36:39], s56 offen offset:2176 nt lds
    s_waitcnt vmcnt(14)
    buffer_load_dwordx4 v15, s[36:39], s56 offen offset:3264 nt lds
    s_add_u32 s57, s57, 34816
    s_cmp_ge_u32 s57, 104448
    s_cselect_b32 s57, s77, s57
    s_add_u32 s62, s62, 1
L_w14:
    s_cmp_ge_i32 s62, s78
    s_cbranch_scc1 L_wfull
    s_add_u32 s72, s72, s79
    s_cbranch_scc1 L_wh14
    s_mov_b32 s55, s44
    s_mov_b32 s56, s45
    v_readlane_b32 s44, v4, s54
    v_readlane_b32 s45, v5, s54
    s_add_u32 s54, s54, 1
    s_nop 0
    s_add_u32 m0, s57, 0
    s_waitcnt vmcnt(13)
    buffer_load_dwordx4 v8, s[32:35], s44 offen offset:0 nt lds
    s_waitcnt vmcnt(13)
    buffer_load_dwordx4 v9, s[32:35], s44 offen offset:1088 nt lds
    s_waitcnt vmcnt(13)
    buffer_load_dwordx4 v10, s[32:35], s44 offen offset:2176 nt lds
    s_waitcnt vmcnt(13)
    buffer_load_dwordx4 v11, s[32:35], s44 offen offset:3264 nt lds
    s_add_u32 m0, s57, 17408
    s_waitcnt vmcnt(13)
    buffer_load_dwordx4 v12, s[36:39], s55 offen offset:0 nt lds
    s_waitcnt vmcnt(13)
    s_sub_u32 s98, s98, 1
    s_cbranch_scc1 L_wskip43
    s_barrier
L_wskip43:
    buffer_load_dwordx4 v13, s[36:39], s55 offen offset:1088 nt lds
    s_waitcnt vmcnt(13)
    buffer_load_dwordx4 v14, s[36:39], s55 offen offset:2176 nt lds
    s_waitcnt vmcnt(13)
    buffer_load_dwordx4 v15, s[36:39], s55 offen offset:3264 nt lds
    s_add_u32 m0, s57, 8704
    s_waitcnt vmcnt(13)
    buffer_load_dwordx4 v8, s[32:35], s45 offen offset:0 nt lds
    s_waitcnt vmcnt(13)
    buffer_load_dwordx4 v9, s[32:35], s45 offen offset:1088 nt lds
    s_waitcnt vmcnt(13)
    buffer_load_dwordx4 v10, s[32:35], s45 offen offset:2176 nt lds
    s_waitcnt vmcnt(13)
    buffer_load_dwordx4 v11, s[32:35], s45 offen offset:3264 nt lds
    s_add_u32 m0, s57, 26112
    s_waitcnt vmcnt(13)
    buffer_load_dwordx4 v12, s[36:39], s56 offen offset:0 nt lds
    s_waitcnt vmcnt(13)
    s_sub_u32 s98, s98, 1
    s_cbranch_scc1 L_wskip44
    s_barrier
L_wskip44:
    buffer_load_dwordx4 v13, s[36:39], s56 offen offset:1088 nt lds
    s_waitcnt vmcnt(13)
    buffer_load_dwordx4 v14, s[36:39], s56 offen offset:2176 nt lds
    s_waitcnt vmcnt(13)
    buffer_load_dwordx4 v15, s[36:39], s56 offen offset:3264 nt lds
    s_add_u32 s57, s57, 34816
    s_cmp_ge_u32 s57, 104448
    s_cselect_b32 s57, s77, s57
    s_add_u32 s62, s62, 1
    s_branch L_w14
L_wh15:
    s_mov_b32 s55, s44
    s_mov_b32 s56, s45
    v_readlane_b32 s44, v4, s54
    v_readlane_b32 s45, v5, s54
    s_add_u32 s54, s54, 1
    s_nop 0
    s_add_u32 m0, s57, 0
    s_waitcnt vmcnt(15)
    buffer_load_dwordx4 v8, s[32:35], s44 offen offset:0 nt lds
    s_waitcnt vmcnt(15)
    buffer_load_dwordx4 v9, s[32:35], s44 offen offset:1088 nt lds
    s_waitcnt vmcnt(15)
    buffer_load_dwordx4 v10, s[32:35], s44 offen offset:2176 nt lds
    s_waitcnt vmcnt(15)
    buffer_load_dwordx4 v11, s[32:35], s44 offen offset:3264 nt lds
    s_add_u32 m0, s57, 17408
    s_waitcnt vmcnt(15)
    buffer_load_dwordx4 v12, s[36:39], s55 offen offset:0 nt lds
    s_waitcnt vmcnt(15)
    buffer_load_dwordx4 v13, s[36:39], s55 offen offset:1088 nt lds
    s_waitcnt vmcnt(15)
    buffer_load_dwordx4 v14, s[36:39], s55 offen offset:2176 nt lds
    s_waitcnt vmcnt(15)
    s_sub_u32 s98, s98, 1
    s_cbranch_scc1 L_wskip45
    s_barrier
L_wskip45:
    buffer_load_dwordx4 v15, s[36:39], s55 offen offset:3264 nt lds
    s_add_u32 m0, s57, 8704
    s_waitcnt vmcnt(15)
    buffer_load_dwordx4 v8, s[32:35], s45 offen offset:0 nt lds
    s_waitcnt vmcnt(15)
    buffer_load_dwordx4 v9, s[32:35], s45 offen offset:1088 nt lds
    s_waitcnt vmcnt(15)
    buffer_load_dwordx4 v10, s[32:35], s45 offen offset:2176 nt lds
    s_waitcnt vmcnt(15)
    buffer_load_dwordx4 v11, s[32:35], s45 offen offset:3264 nt lds
    s_add_u32 m0, s57, 26112
    s_waitcnt vmcnt(15)
    buffer_load_dwordx4 v12, s[36:39], s56 offen offset:0 nt lds
    s_waitcnt vmcnt(15)
    buffer_load_dwordx4 v13, s[36:39], s56 offen offset:1088 nt lds
    s_waitcnt vmcnt(15)
    buffer_load_dwordx4 v14, s[36:39], s56 offen offset:2176 nt lds
    s_waitcnt vmcnt(15)
    s_sub_u32 s98, s98, 1
    s_cbranch_scc1 L_wskip46
    s_barrier
L_wskip46:
    buffer_load_dwordx4 v15, s[36:39], s56 offen offset:3264 nt lds
    s_add_u32 s57, s57, 34816
    s_cmp_ge_u32 s57, 104448
    s_cselect_b32 s57, s77, s57
    s_add_u32 s62, s62, 1
L_w15:
    s_cmp_ge_i32 s62, s78
    s_cbranch_scc1 L_wfull
    s_add_u32 s72, s72, s79
    s_cbranch_scc1 L_wh15
    s_mov_b32 s55, s44
    s_mov_b32 s56, s45
    v_readlane_b32 s44, v4, s54
    v_readlane_b32 s45, v5, s54
    s_add_u32 s54, s54, 1
    s_nop 0
    s_add_u32 m0, s57, 0
    s_waitcnt vmcnt(14)
    buffer_load_dwordx4 v8, s[32:35], s44 offen offset:0 nt lds
    s_waitcnt vmcnt(14)
    buffer_load_dwordx4 v9, s[32:35], s44 offen offset:1088 nt lds
    s_waitcnt vmcnt(14)
    buffer_load_dwordx4 v10, s[32:35], s44 offen offset:2176 nt lds
    s_waitcnt vmcnt(14)
    buffer_load_dwordx4 v11, s[32:35], s44 offen offset:3264 nt lds
    s_add_u32 m0, s57, 17408
    s_waitcnt vmcnt(14)
    buffer_load_dwordx4 v12, s[36:39], s55 offen offset:0 nt lds
    s_waitcnt vmcnt(14)
    buffer_load_dwordx4 v13, s[36:39], s55 offen offset:1088 nt lds
    s_waitcnt vmcnt(14)
    s_sub_u32 s98, s98, 1
    s_cbranch_scc1 L_wskip47
    s_barrier
L_wskip47:
    buffer_load_dwordx4 v14, s[36:39], s55 offen offset:2176 nt lds
    s_waitcnt vmcnt(14)
    buffer_load_dwordx4 v15, s[36:39], s55 offen offset:3264 nt lds
    s_add_u32 m0, s57, 8704
    s_waitcnt vmcnt(14)
    buffer_load_dwordx4 v8, s[32:35], s45 offen offset:0 nt lds
    s_waitcnt vmcnt(14)
    buffer_load_dwordx4 v9, s[32:35], s45 offen offset:1088 nt lds
    s_waitcnt vmcnt(14)
    buffer_load_dwordx4 v10, s[32:35], s45 offen offset:2176 nt lds
    s_waitcnt vmcnt(14)
    buffer_load_dwordx4 v11, s[32:35], s45 offen offset:3264 nt lds
    s_add_u32 m0, s57, 26112
    s_waitcnt vmcnt(14)
    buffer_load_dwordx4 v12, s[36:39], s56 offen offset:0 nt lds
    s_waitcnt vmcnt(14)
    buffer_load_dwordx4 v13, s[36:39], s56 offen offset:1088 nt lds
    s_waitcnt vmcnt(14)
    s_sub_u32 s98, s98, 1
    s_cbranch_scc1 L_wskip48
    s_barrier
L_wskip48:
    buffer_load_dwordx4 v14, s[36:39], s56 offen offset:2176 nt lds
    s_waitcnt vmcnt(14)
    buffer_load_dwordx4 v15, s[36:39], s56 offen offset:3264 nt lds
    s_add_u32 s57, s57, 34816
    s_cmp_ge_u32 s57, 104448
    s_cselect_b32 s57, s77, s57
    s_add_u32 s62, s62, 1
    s_branch L_w15
L_wfull:
    s_lshl_b32 s79, s96, 16
    s_lshr_b32 s80, s96, 16
    s_mov_b32 s97, 0x7fff
    s_mov_b32 s78, s99
    s_cmp_eq_u32 s62, s95
    s_cbranch_scc0 L_wf2
    s_barrier
    s_mov_b32 s95, 0x7fff
L_wf2:
    s_min_i32 s78, s78, s95
    s_cmp_ge_i32 s62, s78
    s_cbranch_scc0 L_disp
L_wend:
    s_cmp_ge_i32 s62, s83
    s_cbranch_scc1 L_wdone
    s_mov_b32 s55, s44
    s_mov_b32 s56, s45
    v_readlane_b32 s44, v4, s54
    v_readlane_b32 s45, v5, s54
    s_add_u32 s54, s54, 1
    s_nop 0
    s_add_u32 m0, s57, 0
    s_waitcnt vmcnt(15)
    buffer_load_dwordx4 v8, s[32:35], s44 offen offset:0 nt lds
    s_waitcnt vmcnt(15)
    buffer_load_dwordx4 v9, s[32:35], s44 offen offset:1088 nt lds
    s_waitcnt vmcnt(15)
    buffer_load_dwordx4 v10, s[32:35], s44 offen offset:2176 nt lds
    s_waitcnt vmcnt(15)
    buffer_load_dwordx4 v11, s[32:35], s44 offen offset:3264 nt lds
    s_add_u32 m0, s57, 17408
    s_waitcnt vmcnt(15)
    buffer_load_dwordx4 v12, s[36:39], s55 offen offset:0 nt lds
    s_waitcnt vmcnt(15)
    buffer_load_dwordx4 v13, s[36:39], s55 offen offset:1088 nt lds
    s_waitcnt vmcnt(15)
    buffer_load_dwordx4 v14, s[36:39], s55 offen offset:2176 nt lds
    s_waitcnt vmcnt(15)
    s_cmp_eq_u32 s82, 1
    s_mov_b32 s82, 0
    s_cbranch_scc1 L_wskip49
    s_barrier
L_wskip49:
    buffer_load_dwordx4 v15, s[36:39], s55 offen offset:3264 nt lds
    s_add_u32 m0, s57, 8704
    s_waitcnt vmcnt(15)
    buffer_load_dwordx4 v8, s[32:35], s45 offen offset:0 nt lds
    s_waitcnt vmcnt(15)
    buffer_load_dwordx4 v9, s[32:35], s45 offen offset:1088 nt lds
    s_waitcnt vmcnt(15)
    buffer_load_dwordx4 v10, s[32:35], s45 offen offset:2176 nt lds
    s_waitcnt vmcnt(15)
    buffer_load_dwordx4 v11, s[32:35], s45 offen offset:3264 nt lds
    s_add_u32 m0, s57, 26112
    s_waitcnt vmcnt(15)
    buffer_load_dwordx4 v12, s[36:39], s56 offen offset:0 nt lds
    s_waitcnt vmcnt(15)
    buffer_load_dwordx4 v13, s[36:39], s56 offen offset:1088 nt lds
    s_waitcnt vmcnt(15)
    buffer_load_dwordx4 v14, s[36:39], s56 offen offset:2176 nt lds
    s_waitcnt vmcnt(15)
    s_barrier
    buffer_load_dwordx4 v15, s[36:39], s56 offen offset:3264 nt lds
    s_add_u32 s57, s57, 34816
    s_cmp_ge_u32 s57, 104448
    s_cselect_b32 s57, s77, s57
    s_add_u32 s62, s62, 1
    s_branch L_wend
L_wdone:
    s_cmp_eq_u32 s48, 1
    s_cbranch_scc1 L_wl00
    s_mov_b32 s55, s44
    s_mov_b32 s56, s45
    s_add_u32 m0, s57, 17408
    s_nop 0
    buffer_load_dwordx4 v12, s[36:39], s55 offen offset:0 nt lds
    buffer_load_dwordx4 v13, s[36:39], s55 offen offset:1088 nt lds
    buffer_load_dwordx4 v14, s[36:39], s55 offen offset:2176 nt lds
    buffer_load_dwordx4 v15, s[36:39], s55 offen offset:3264 nt lds
    s_add_u32 m0, s57, 26112
    s_nop 0
    buffer_load_dwordx4 v12, s[36:39], s56 offen offset:0 nt lds
    buffer_load_dwordx4 v13, s[36:39], s56 offen offset:1088 nt lds
    buffer_load_dwordx4 v14, s[36:39], s56 offen offset:2176 nt lds
    buffer_load_dwordx4 v15, s[36:39], s56 offen offset:3264 nt lds
    s_add_u32 s57, s57, 34816
    s_cmp_ge_u32 s57, 104448
    s_cselect_b32 s57, s77, s57
L_wl00:
    s_cmp_eq_u32 s23, 1
    s_cselect_b32 s24, s51, 1
    s_cmp_gt_u32 s24, 1
    s_cbranch_scc1 L_lown
    s_mul_i32 s24, s66, 73728
    s_add_u32 s24, s24, 36864
    s_lshl_b32 s25, s66, 15
    s_cmp_eq_u32 s23, 2
    s_cselect_b32 s68, s18, s14
    s_cselect_b32 s69, s19, s15
    s_cselect_b32 s24, s24, s25
    s_cselect_b32 s70, 537395200, 0
    s_max_u32 s70, s70, 4194304
    s_and_b32 s69, s69, 0xffff
    s_mov_b32 s71, 0x20000
    s_lshl_b32 s25, s73, 14
    s_add_u32 s24, s24, s25
    s_add_u32 s25, s24, 8192
    v_lshlrev_b32 v30, 7, v1
    buffer_load_dword v31, v30, s[68:71], s24 offen
    buffer_load_dword v33, v30, s[68:71], s25 offen
    s_cmp_eq_u32 s48, 1
    s_cbranch_scc1 L_wl1
    s_cmp_eq_u32 s82, 1
    s_cbranch_scc1 L_wl0
    s_waitcnt vmcnt(18)
    s_barrier
L_wl0:
    s_waitcnt vmcnt(10)
    s_barrier
L_wl1:
    s_cmp_eq_u32 s84, 0
    s_cbranch_scc1 L_wlast
    s_mov_b32 s48, s84
    s_mov_b32 s49, s85
    s_mov_b32 s50, 1
    s_mov_b32 s51, 3
    s_mov_b32 s23, 2
    s_mov_b32 s22, s86
    s_mov_b32 s26, s87
    s_mov_b32 s60, s88
    s_mov_b32 s84, 0
    s_add_u32 s27, s26, 15
    s_lshr_b32 s27, s27, 4
    s_lshl3_add_u32 s66, s22, s21
    v_add_u32 v3, 2560, v3
    s_lshl3_add_u32 s24, s22, s21
    s_lshl_b32 s24, s24, 15
    s_lshl_b32 s25, s73, 14
    s_add_u32 s24, s24, s25
    s_mul_i32 s25, s73, 17408
    s_add_u32 s25, s25, 104448
    s_mov_b32 m0, s25
    s_add_u32 s25, s25, 4352
    buffer_load_dwordx4 v24, s[40:43], s24 offen offset:0  lds
    buffer_load_dwordx4 v25, s[40:43], s24 offen offset:1088  lds
    buffer_load_dwordx4 v26, s[40:43], s24 offen offset:2176  lds
    buffer_load_dwordx4 v27, s[40:43], s24 offen offset:3264  lds
    s_add_u32 s24, s24, 4096
    s_mov_b32 m0, s25
    s_add_u32 s25, s25, 4352
    buffer_load_dwordx4 v24, s[40:43], s24 offen offset:0  lds
    buffer_load_dwordx4 v25, s[40:43], s24 offen offset:1088  lds
    buffer_load_dwordx4 v26, s[40:43], s24 offen offset:2176  lds
    buffer_load_dwordx4 v27, s[40:43], s24 offen offset:3264  lds
    s_add_u32 s24, s24, 4096
    s_mov_b32 m0, s25
    s_add_u32 s25, s25, 4352
    buffer_load_dwordx4 v24, s[40:43], s24 offen offset:0  lds
    buffer_load_dwordx4 v25, s[40:43], s24 offen offset:1088  lds
    buffer_load_dwordx4 v26, s[40:43], s24 offen offset:2176  lds
    buffer_load_dwordx4 v27, s[40:43], s24 offen offset:3264  lds
    s_add_u32 s24, s24, 4096
    s_mov_b32 m0, s25
    s_add_u32 s25, s25, 4352
    buffer_load_dwordx4 v24, s[40:43], s24 offen offset:0  lds
    buffer_load_dwordx4 v25, s[40:43], s24 offen offset:1088  lds
    buffer_load_dwordx4 v26, s[40:43], s24 offen offset:2176  lds
    buffer_load_dwordx4 v27, s[40:43], s24 offen offset:3264  lds
    s_waitcnt vmcnt(22)
    s_barrier
    ds_read2_b32 v[4:5], v3 offset0:0 offset1:2
    s_waitcnt vmcnt(18)
    s_barrier
    s_waitcnt lgkmcnt(0)
    v_min_u32 v4, 134316032, v4
    v_min_u32 v5, 134316032, v5
    s_mov_b32 s54, 0
    s_mov_b32 s55, s44
    s_mov_b32 s56, s45
    v_readlane_b32 s44, v4, s54
    v_readlane_b32 s45, v5, s54
    s_add_u32 s54, s54, 1
    s_nop 0
    s_add_u32 s58, s77, 139264
    s_add_u32 m0, s58, 0
    s_nop 0
    buffer_load_dwordx4 v8, s[32:35], s44 offen offset:0 nt lds
    buffer_load_dwordx4 v9, s[32:35], s44 offen offset:1088 nt lds
    buffer_load_dwordx4 v10, s[32:35], s44 offen offset:2176 nt lds
    buffer_load_dwordx4 v11, s[32:35], s44 offen offset:3264 nt lds
    s_add_u32 m0, s58, 8704
    s_nop 0
    buffer_load_dwordx4 v8, s[32:35], s45 offen offset:0 nt lds
    buffer_load_dwordx4 v9, s[32:35], s45 offen offset:1088 nt lds
    buffer_load_dwordx4 v10, s[32:35], s45 offen offset:2176 nt lds
    buffer_load_dwordx4 v11, s[32:35], s45 offen offset:3264 nt lds
    s_mov_b32 s55, s44
    s_mov_b32 s56, s45
    v_readlane_b32 s44, v4, s54
    v_readlane_b32 s45, v5, s54
    s_add_u32 s54, s54, 1
    s_nop 0
    s_add_u32 m0, s57, 0
    s_waitcnt vmcnt(11)
    buffer_load_dwordx4 v8, s[32:35], s44 offen offset:0 nt lds
    s_waitcnt vmcnt(11)
    buffer_load_dwordx4 v9, s[32:35], s44 offen offset:1088 nt lds
    s_waitcnt vmcnt(11)
    buffer_load_dwordx4 v10, s[32:35], s44 offen offset:2176 nt lds
    s_waitcnt vmcnt(11)
    s_barrier
    buffer_load_dwordx4 v11, s[32:35], s44 offen offset:3264 nt lds
    s_add_u32 m0, s57, 17408
    s_waitcnt vmcnt(11)
    buffer_load_dwordx4 v12, s[36:39], s55 offen offset:0 nt lds
    s_waitcnt vmcnt(11)
    buffer_load_dwordx4 v13, s[36:39], s55 offen offset:1088 nt lds
    s_waitcnt vmcnt(11)
    buffer_load_dwordx4 v14, s[36:39], s55 offen offset:2176 nt lds
    s_waitcnt vmcnt(11)
    buffer_load_dwordx4 v15, s[36:39], s55 offen offset:3264 nt lds
    s_add_u32 m0, s57, 8704
    s_waitcnt vmcnt(11)
    buffer_load_dwordx4 v8, s[32:35], s45 offen offset:0 nt lds
    s_waitcnt vmcnt(11)
    buffer_load_dwordx4 v9, s[32:35], s45 offen offset:1088 nt lds
    s_waitcnt vmcnt(11)
    buffer_load_dwordx4 v10, s[32:35], s45 offen offset:2176 nt lds
    s_waitcnt vmcnt(11)
    s_barrier
    buffer_load_dwordx4 v11, s[32:35], s45 offen offset:3264 nt lds
    s_add_u32 m0, s57, 26112
    s_waitcnt vmcnt(11)
    buffer_load_dwordx4 v12, s[36:39], s56 offen offset:0 nt lds
    s_waitcnt vmcnt(11)
    buffer_load_dwordx4 v13, s[36:39], s56 offen offset:1088 nt lds
    s_waitcnt vmcnt(11)
    buffer_load_dwordx4 v14, s[36:39], s56 offen offset:2176 nt lds
    s_waitcnt vmcnt(11)
    buffer_load_dwordx4 v15, s[36:39], s56 offen offset:3264 nt lds
    s_add_u32 s57, s57, 34816
    s_cmp_ge_u32 s57, 104448
    s_cselect_b32 s57, s77, s57
    s_branch L_wok
L_wlast:
    s_waitcnt vmcnt(6)
    s_barrier
    s_waitcnt vmcnt(2)
    s_barrier
    s_branch L_lfin
L_lown:
    s_lshl_b32 s58, s66, 7
    s_lshl_b32 s24, s73, 4
    s_add_u32 s58, s58, s24
    s_add_u32 s58, s58, 33554432
    s_mov_b32 s28, s18
    s_and_b32 s29, s19, 0xffff
    s_mov_b32 s30, 537395200
    s_mov_b32 s31, 0x20000
    s_mov_b32 s68, s14
    s_and_b32 s69, s15, 0xffff
    s_mov_b32 s70, 4194304
    s_mov_b32 s71, 0x20000
    s_cmp_eq_u32 s51, 3
    s_cselect_b32 s59, 15, 5
    s_sub_u32 s63, s57, s77
    s_mov_b32 s62, 2
    s_mov_b32 s67, 0
    s_mov_b32 s61, 0x400000
    v_mov_b32 v3, 0
    s_lshl_b32 s64, s73, 14
    s_lshl_b32 s65, s66, 15
    s_add_u32 s65, s65, s64
    s_mul_i32 s54, s66, 73728
    v_and_b32 v30, 15, v1
    v_bfe_u32 v31, v1, 4, 1
    v_lshlrev_b32 v30, 4, v30
    v_lshl_add_u32 v30, v31, 10, v30
    s_cmp_eq_u32 s48, 1
    s_cbranch_scc0 L_lo2
    s_load_dwordx4 s[44:47], s[18:19], s58 glc
    s_branch L_lp
L_lo2:
    s_cmp_eq_u32 s82, 1
    s_cbranch_scc1 L_lo3
    s_waitcnt vmcnt(16)
    s_barrier
L_lo3:
    s_waitcnt vmcnt(8)
    s_load_dwordx4 s[44:47], s[18:19], s58 glc
    s_barrier
L_lp:
    s_waitcnt lgkmcnt(0)
    s_lshl1_add_u32 s24, s45, s44
    s_lshl2_add_u32 s24, s46, s24
    s_lshl3_add_u32 s24, s47, s24
    s_cmp_eq_u32 s24, s59
    s_cbranch_scc0 L_lno
    s_add_u32 s25, s64, 104448
    s_mov_b32 s24, s65
    s_mov_b32 m0, s25
    s_add_u32 s25, s25, 4096
    buffer_load_dwordx4 v23, s[68:71], s24 offen offset:0  lds
    buffer_load_dwordx4 v23, s[68:71], s24 offen offset:1024  lds
    buffer_load_dwordx4 v23, s[68:71], s24 offen offset:2048  lds
    buffer_load_dwordx4 v23, s[68:71], s24 offen offset:3072  lds
    s_add_u32 s24, s24, 4096
    s_mov_b32 m0, s25
    s_add_u32 s25, s25, 4096
    buffer_load_dwordx4 v23, s[68:71], s24 offen offset:0  lds
    buffer_load_dwordx4 v23, s[68:71], s24 offen offset:1024  lds
    buffer_load_dwordx4 v23, s[68:71], s24 offen offset:2048  lds
    buffer_load_dwordx4 v23, s[68:71], s24 offen offset:3072  lds
    s_add_u32 s24, s24, 4096
    s_mov_b32 m0, s25
    s_add_u32 s25, s25, 4096
    buffer_load_dwordx4 v23, s[68:71], s24 offen offset:0  lds
    buffer_load_dwordx4 v23, s[68:71], s24 offen offset:1024  lds
    buffer_load_dwordx4 v23, s[68:71], s24 offen offset:2048  lds
    buffer_load_dwordx4 v23, s[68:71], s24 offen offset:3072  lds
    s_add_u32 s24, s24, 4096
    s_mov_b32 m0, s25
    s_add_u32 s25, s25, 4096
    buffer_load_dwordx4 v23, s[68:71], s24 offen offset:0  lds
    buffer_load_dwordx4 v23, s[68:71], s24 offen offset:1024  lds
    buffer_load_dwordx4 v23, s[68:71], s24 offen offset:2048  lds
    buffer_load_dwordx4 v23, s[68:71], s24 offen offset:3072  lds
    s_add_u32 s24, s24, 4096
    s_lshl_b32 s25, s73, 9
    s_add_u32 s25, s25, 104448
    s_add_u32 m0, s25, 32768
    s_lshl_b32 s25, s73, 11
    s_add_u32 s25, s25, s54
    s_add_u32 s25, s25, 32768
    s_mov_b32 exec_hi, 0
    buffer_load_dwordx4 v30, s[28:31], s25 offen  lds
    s_mov_b32 exec_hi, -1
    s_cmp_eq_u32 s62, 2
    s_cbranch_scc0 L_lf1
    s_waitcnt vmcnt(21)
    s_barrier
L_lf1:
    s_cmp_eq_u32 s51, 3
    s_cbranch_scc1 L_lf3
    s_cmp_eq_u32 s62, 0
    s_cbranch_scc1 L_lbp
    s_waitcnt vmcnt(17)
    s_barrier
    s_branch L_lbp
L_lf3:
    s_add_u32 s25, s64, s63
    s_add_u32 s54, s54, 36864
    s_add_u32 s24, s54, s64
    s_mov_b32 m0, s25
    s_add_u32 s25, s25, 4096
    buffer_load_dwordx4 v23, s[28:31], s24 offen offset:0  lds
    buffer_load_dwordx4 v23, s[28:31], s24 offen offset:1024  lds
    buffer_load_dwordx4 v23, s[28:31], s24 offen offset:2048  lds
    buffer_load_dwordx4 v23, s[28:31], s24 offen offset:3072  lds
    s_add_u32 s24, s24, 4096
    s_mov_b32 m0, s25
    s_add_u32 s25, s25, 4096
    buffer_load_dwordx4 v23, s[28:31], s24 offen offset:0  lds
    buffer_load_dwordx4 v23, s[28:31], s24 offen offset:1024  lds
    buffer_load_dwordx4 v23, s[28:31], s24 offen offset:2048  lds
    buffer_load_dwordx4 v23, s[28:31], s24 offen offset:3072  lds
    s_add_u32 s24, s24, 4096
    s_mov_b32 m0, s25
    s_add_u32 s25, s25, 4096
    buffer_load_dwordx4 v23, s[28:31], s24 offen offset:0  lds
    buffer_load_dwordx4 v23, s[28:31], s24 offen offset:1024  lds
    buffer_load_dwordx4 v23, s[28:31], s24 offen offset:2048  lds
    buffer_load_dwordx4 v23, s[28:31], s24 offen offset:3072  lds
    s_add_u32 s24, s24, 4096
    s_mov_b32 m0, s25
    s_add_u32 s25, s25, 4096
    buffer_load_dwordx4 v23, s[28:31], s24 offen offset:0  lds
    buffer_load_dwordx4 v23, s[28:31], s24 offen offset:1024  lds
    buffer_load_dwordx4 v23, s[28:31], s24 offen offset:2048  lds
    buffer_load_dwordx4 v23, s[28:31], s24 offen offset:3072  lds
    s_add_u32 s24, s24, 4096
    s_lshl_b32 s25, s73, 9
    s_add_u32 s25, s25, s63
    s_add_u32 m0, s25, 32768
    s_lshl_b32 s25, s73, 11
    s_add_u32 s25, s25, s54
    s_add_u32 s25, s25, 32768
    s_mov_b32 exec_hi, 0
    buffer_load_dwordx4 v30, s[28:31], s25 offen  lds
    s_mov_b32 exec_hi, -1
    s_cmp_eq_u32 s62, 0
    s_cbranch_scc1 L_lbp
    s_waitcnt vmcnt(34)
    s_barrier
    s_branch L_lbp
L_lno:
    s_or_b32 s24, s24, s67
    s_cmp_eq_u32 s24, s59
    s_cbranch_scc1 L_lgo
    s_cmp_eq_u32 s62, 0
    s_cbranch_scc1 L_lp2
    s_waitcnt vmcnt(4)
    s_cmp_eq_u32 s62, 2
    s_cbranch_scc1 L_lp1
    s_waitcnt vmcnt(0)
L_lp1:
    s_load_dwordx4 s[44:47], s[18:19], s58 glc
    s_barrier
    s_sub_u32 s62, s62, 1
    s_branch L_lp
L_lp2:
    s_load_dwordx4 s[44:47], s[18:19], s58 glc
    s_sub_u32 s61, s61, 1
    s_cbranch_scc1 L_lgo2
    s_and_b32 s24, s61, 15
    s_cbranch_scc1 L_lp
    s_mov_b32 s32, s16
    s_and_b32 s33, s17, 0xffff
    s_mov_b32 s34, 256
    s_mov_b32 s35, 0x20000
    s_lshr_b32 s24, s66, 1
    s_lshl_b32 s24, s24, 2
    buffer_load_dword v31, v3, s[32:35], s24 offen sc1
    s_lshl2_add_u32 s25, s73, s91
    s_add_u32 s25, s25, 4
    s_waitcnt vmcnt(0)
    v_readfirstlane_b32 s24, v31
    s_nop 1
    s_lshr_b32 s24, s24, s25
    s_and_b32 s67, s24, s59
    s_branch L_lp
L_lgo2:
    s_waitcnt lgkmcnt(0)
L_lgo:
    buffer_inv sc1
    s_waitcnt vmcnt(0)
    s_mov_b32 s39, 0x20000
    s_lshl1_add_u32 s52, s73, 0
    s_lshl1_add_u32 s24, s66, 0
    s_mul_i32 s24, s24, 36864
    s_bitcmp1_b32 s67, 0
    s_cselect_b32 s25, 16777216, 0
    s_add_u32 s24, s24, s25
    s_lshl_b32 s25, s52, 8
    s_add_u32 s25, s25, 104448
    s_add_u32 m0, s25, 32768
    s_lshl_b32 s25, s52, 10
    s_add_u32 s25, s25, s24
    s_add_u32 s25, s25, 32768
    s_mov_b64 exec, 0xffff
    buffer_load_dwordx4 v23, s[28:31], s25 offen sc1 lds
    s_mov_b64 exec, -1
    s_lshl_b32 s25, s66, 15
    s_bitcmp1_b32 s67, 0
    s_cselect_b32 s36, s28, s68
    s_cselect_b32 s37, s29, s69
    s_cselect_b32 s38, s30, s70
    s_cselect_b32 s24, s24, s25
    s_lshl_b32 s25, s52, 13
    s_add_u32 s24, s24, s25
    s_add_u32 s25, s25, 104448
    s_mov_b32 m0, s25
    s_add_u32 s25, s25, 4096
    buffer_load_dwordx4 v23, s[36:39], s24 offen offset:0 sc1 lds
    buffer_load_dwordx4 v23, s[36:39], s24 offen offset:1024 sc1 lds
    buffer_load_dwordx4 v23, s[36:39], s24 offen offset:2048 sc1 lds
    buffer_load_dwordx4 v23, s[36:39], s24 offen offset:3072 sc1 lds
    s_add_u32 s24, s24, 4096
    s_mov_b32 m0, s25
    s_add_u32 s25, s25, 4096
    buffer_load_dwordx4 v23, s[36:39], s24 offen offset:0 sc1 lds
    buffer_load_dwordx4 v23, s[36:39], s24 offen offset:1024 sc1 lds
    buffer_load_dwordx4 v23, s[36:39], s24 offen offset:2048 sc1 lds
    buffer_load_dwordx4 v23, s[36:39], s24 offen offset:3072 sc1 lds
    s_add_u32 s24, s24, 4096
    s_lshl1_add_u32 s52, s73, 1
    s_lshl1_add_u32 s24, s66, 0
    s_mul_i32 s24, s24, 36864
    s_bitcmp1_b32 s67, 2
    s_cselect_b32 s25, 16777216, 0
    s_add_u32 s24, s24, s25
    s_lshl_b32 s25, s52, 8
    s_add_u32 s25, s25, 104448
    s_add_u32 m0, s25, 32768
    s_lshl_b32 s25, s52, 10
    s_add_u32 s25, s25, s24
    s_add_u32 s25, s25, 32768
    s_mov_b64 exec, 0xffff
    buffer_load_dwordx4 v23, s[28:31], s25 offen sc1 lds
    s_mov_b64 exec, -1
    s_lshl_b32 s25, s66, 15
    s_bitcmp1_b32 s67, 2
    s_cselect_b32 s36, s28, s68
    s_cselect_b32 s37, s29, s69
    s_cselect_b32 s38, s30, s70
    s_cselect_b32 s24, s24, s25
    s_lshl_b32 s25, s52, 13
    s_add_u32 s24, s24, s25
    s_add_u32 s25, s25, 104448
    s_mov_b32 m0, s25
    s_add_u32 s25, s25, 4096
    buffer_load_dwordx4 v23, s[36:39], s24 offen offset:0 sc1 lds
    buffer_load_dwordx4 v23, s[36:39], s24 offen offset:1024 sc1 lds
    buffer_load_dwordx4 v23, s[36:39], s24 offen offset:2048 sc1 lds
    buffer_load_dwordx4 v23, s[36:39], s24 offen offset:3072 sc1 lds
    s_add_u32 s24, s24, 4096
    s_mov_b32 m0, s25
    s_add_u32 s25, s25, 4096
    buffer_load_dwordx4 v23, s[36:39], s24 offen offset:0 sc1 lds
    buffer_load_dwordx4 v23, s[36:39], s24 offen offset:1024 sc1 lds
    buffer_load_dwordx4 v23, s[36:39], s24 offen offset:2048 sc1 lds
    buffer_load_dwordx4 v23, s[36:39], s24 offen offset:3072 sc1 lds
    s_add_u32 s24, s24, 4096
    s_cmp_eq_u32 s51, 3
    s_cbranch_scc0 L_lbp
    s_lshl1_add_u32 s52, s73, 0
    s_lshl1_add_u32 s24, s66, 1
    s_mul_i32 s24, s24, 36864
    s_bitcmp1_b32 s67, 1
    s_cselect_b32 s25, 16777216, 0
    s_add_u32 s24, s24, s25
    s_lshl_b32 s25, s52, 8
    s_add_u32 s25, s25, s63
    s_add_u32 m0, s25, 32768
    s_lshl_b32 s25, s52, 10
    s_add_u32 s25, s25, s24
    s_add_u32 s25, s25, 32768
    s_mov_b64 exec, 0xffff
    buffer_load_dwordx4 v23, s[28:31], s25 offen sc1 lds
    s_mov_b64 exec, -1
    s_lshl_b32 s25, s52, 13
    s_add_u32 s24, s24, s25
    s_add_u32 s25, s25, s63
    s_mov_b32 m0, s25
    s_add_u32 s25, s25, 4096
    buffer_load_dwordx4 v23, s[28:31], s24 offen offset:0 sc1 lds
    buffer_load_dwordx4 v23, s[28:31], s24 offen offset:1024 sc1 lds
    buffer_load_dwordx4 v23, s[28:31], s24 offen offset:2048 sc1 lds
    buffer_load_dwordx4 v23, s[28:31], s24 offen offset:3072 sc1 lds
    s_add_u32 s24, s24, 4096
    s_mov_b32 m0, s25
    s_add_u32 s25, s25, 4096
    buffer_load_dwordx4 v23, s[28:31], s24 offen offset:0 sc1 lds
    buffer_load_dwordx4 v23, s[28:31], s24 offen offset:1024 sc1 lds
    buffer_load_dwordx4 v23, s[28:31], s24 offen offset:2048 sc1 lds
    buffer_load_dwordx4 v23, s[28:31], s24 offen offset:3072 sc1 lds
    s_add_u32 s24, s24, 4096
    s_lshl1_add_u32 s52, s73, 1
    s_lshl1_add_u32 s24, s66, 1
    s_mul_i32 s24, s24, 36864
    s_bitcmp1_b32 s67, 3
    s_cselect_b32 s25, 16777216, 0
    s_add_u32 s24, s24, s25
    s_lshl_b32 s25, s52, 8
    s_add_u32 s25, s25, s63
    s_add_u32 m0, s25, 32768
    s_lshl_b32 s25, s52, 10
    s_add_u32 s25, s25, s24
    s_add_u32 s25, s25, 32768
    s_mov_b64 exec, 0xffff
    buffer_load_dwordx4 v23, s[28:31], s25 offen sc1 lds
    s_mov_b64 exec, -1
    s_lshl_b32 s25, s52, 13
    s_add_u32 s24, s24, s25
    s_add_u32 s25, s25, s63
    s_mov_b32 m0, s25
    s_add_u32 s25, s25, 4096
    buffer_load_dwordx4 v23, s[28:31], s24 offen offset:0 sc1 lds
    buffer_load_dwordx4 v23, s[28:31], s24 offen offset:1024 sc1 lds
    buffer_load_dwordx4 v23, s[28:31], s24 offen offset:2048 sc1 lds
    buffer_load_dwordx4 v23, s[28:31], s24 offen offset:3072 sc1 lds
    s_add_u32 s24, s24, 4096
    s_mov_b32 m0, s25
    s_add_u32 s25, s25, 4096
    buffer_load_dwordx4 v23, s[28:31], s24 offen offset:0 sc1 lds
    buffer_load_dwordx4 v23, s[28:31], s24 offen offset:1024 sc1 lds
    buffer_load_dwordx4 v23, s[28:31], s24 offen offset:2048 sc1 lds
    buffer_load_dwordx4 v23, s[28:31], s24 offen offset:3072 sc1 lds
    s_add_u32 s24, s24, 4096
L_lbp:
    s_waitcnt vmcnt(0)
    s_barrier
L_lfin:
L_end:
    s_endpgm
.section .rodata,"a"
.p2align 6
.amdhsa_kernel standalone__paged_block_table_kv_pagedattention__sampling_kernel
  .amdhsa_next_free_vgpr 256
  .amdhsa_next_free_sgpr 102
  .amdhsa_accum_offset 256
  .amdhsa_group_segment_fixed_size 0
  .amdhsa_kernarg_size 64
  .amdhsa_user_sgpr_count 2
  .amdhsa_user_sgpr_kernarg_segment_ptr 1
  .amdhsa_system_sgpr_workgroup_id_x 1
.end_amdhsa_kernel
```
